```python
import torch

def _softmax(x, axis=-1):
    return torch.softmax(x, dim=axis)
def _gelu(x):
    return torch.nn.functional.gelu(x, approximate="tanh")
def _silu(x):
    return torch.nn.functional.silu(x)
def _sigmoid(x):
    return torch.sigmoid(x)
def _layernorm(x, axis=-1, eps=1e-5):
    m = x.mean(dim=axis, keepdim=True)
    v = x.var(dim=axis, keepdim=True, unbiased=False)
    return (x - m) / torch.sqrt(v + eps)
def _scatter_add(tgt, idx, src, axis=0):
    return tgt.clone().index_add_(axis, idx, src)
def _segment_sum(src, seg, n):
    out = torch.zeros((n,) + src.shape[1:], dtype=src.dtype)
    return out.index_add_(0, seg, src)
def _pad(x, pw):
    flat = tuple(v for pair in reversed(pw) for v in pair)
    return torch.nn.functional.pad(x, flat)

kernel_name = 'standalone__mha_block_cached__near_ridge'

def setup_inputs():

    _w = (lambda a: (lambda t: t.to(torch.bfloat16) if t.is_floating_point() else t)(torch.as_tensor(a)))
    B, Sq, D = 8, 192, 576
    H, Sk, Dh = 32, 1024, 128
    return {
        "x": _w((lambda *s: torch.randn(*s, dtype=torch.bfloat16) * 0.8)(B, Sq, D)),
        "k_cache": _w((lambda *s: torch.randn(*s, dtype=torch.bfloat16) * 0.8)(B, H, Sk, Dh)),
        "v_cache": _w((lambda *s: torch.randn(*s, dtype=torch.bfloat16) * 0.05)(B, H, Sk, Dh)),
        "wq": _w((lambda *s: torch.randn(*s, dtype=torch.bfloat16) * 0.8)(D, H * Dh) * (D ** -0.5)),
        "wo": _w((lambda *s: torch.randn(*s, dtype=torch.bfloat16) * 0.05)(H * Dh, D) * ((H * Dh) ** -0.5)),
    }

def reference(x, k_cache, v_cache, wq, wo):
    B, Sq, D = x.shape
    H, Dh = 32, 128
    q = (lambda x, *d: x.permute(*d))((x @ wq).reshape(B, Sq, H, Dh), 0, 2, 1, 3)
    scores = torch.einsum("bhqd,bhkd->bhqk", q, k_cache) * (Dh ** -0.5)
    p = _softmax(scores, axis=-1)
    o = torch.einsum("bhqk,bhkd->bhqd", p, v_cache)
    return (lambda x, *d: x.permute(*d))(o, 0, 2, 1, 3).reshape(B, Sq, H * Dh) @ wo
```

```asm
; @launch grid=(256,1,1) block=(512,1,1) lds=163840
.amdgcn_target "amdgcn-amd-amdhsa--gfx950"
.text
.globl standalone__mha_block_cached__near_ridge_kernel
.p2align 8
.type standalone__mha_block_cached__near_ridge_kernel,@function
standalone__mha_block_cached__near_ridge_kernel:
    s_cmp_ge_u32 s2, 256
    s_cbranch_scc1 K1_END
    s_load_dwordx8 s[4:11], s[0:1], 0
    s_load_dwordx8 s[12:19], s[0:1], 32
    v_lshrrev_b32 v1, 6, v0
    v_and_b32 v0, 63, v0
    v_readfirstlane_b32 s42, v1
    s_and_b32 s43, s2, 7
    s_lshr_b32 s44, s2, 3
    s_and_b32 s40, s43, 1
    s_lshl_b32 s40, s40, 2
    s_and_b32 s45, s44, 3
    s_add_u32 s40, s40, s45
    s_lshr_b32 s41, s43, 1
    s_lshl_b32 s41, s41, 3
    s_lshr_b32 s46, s44, 2
    s_add_u32 s41, s41, s46
    s_mul_i32 s45, s45, 8
    s_mul_i32 s46, s46, 4
    s_add_u32 s45, s45, s46
    s_and_b32 s45, s45, 31
    s_mul_i32 s45, s45, 8
    s_lshr_b32 s45, s45, 5
    s_add_u32 s45, s45, 1
    s_lshl_b32 s100, s45, 7
    s_lshl_b32 s101, s45, 19
    s_mov_b32 s57, 0
    s_mov_b32 s58, 0
    s_lshl_b32 s45, s40, 5
    s_add_u32 s45, s45, s41
    s_lshl_b32 s45, s45, 18
    s_mul_i32 s46, s40, 221184
    s_lshl_b32 s47, s41, 8
    s_mul_i32 s48, s40, 1572864
    s_and_b32 s53, s42, 3
    s_lshr_b32 s54, s42, 2
    v_bfe_u32 v4, v0, 2, 3
    v_lshrrev_b32 v5, 5, v0
    v_and_b32 v3, 3, v0
    v_lshrrev_b32 v7, 2, v4
    v_lshlrev_b32 v8, 1, v7
    v_xor_b32 v6, v3, v8
    v_lshlrev_b32 v6, 4, v6
    v_lshl_add_u32 v6, v5, 6, v6
    s_lshr_b32 s43, s53, 1
    s_and_b32 s44, s42, 1
    v_and_b32 v9, 3, v4
    v_lshl_add_u32 v9, v7, 3, v9
    s_lshl_b32 s55, s43, 4
    s_lshl_b32 s62, s54, 2
    s_add_u32 s55, s55, s62
    v_add_u32 v9, s55, v9
    v_lshl_add_u32 v9, v9, 13, v6
    s_lshl_b32 s55, s44, 7
    v_add_u32 v211, s55, v9
    v_add_u32 v212, 261120, v211
    s_lshl_b32 s60, s42, 11
    s_mul_i32 s63, s42, 3
    s_add_u32 s62, s63, 0
    s_and_b32 s56, s62, 1
    s_lshl_b32 s56, s56, 3
    s_add_u32 s56, s56, 12
    s_lshr_b32 s62, s62, 1
    s_lshl_b32 s62, s62, 4
    v_add_u32 v9, s56, v4
    v_and_b32 v9, 15, v9
    v_add_u32 v9, s62, v9
    v_mul_u32_u24 v9, 1152, v9
    v_add_u32 v9, v9, v6
    v_mov_b32 v208, v9
    s_add_u32 s62, s63, 1
    s_and_b32 s56, s62, 1
    s_lshl_b32 s56, s56, 3
    s_add_u32 s56, s56, 12
    s_lshr_b32 s62, s62, 1
    s_lshl_b32 s62, s62, 4
    v_add_u32 v9, s56, v4
    v_and_b32 v9, 15, v9
    v_add_u32 v9, s62, v9
    v_mul_u32_u24 v9, 1152, v9
    v_add_u32 v9, v9, v6
    v_subrev_u32 v209, 1024, v9
    s_add_u32 s62, s63, 2
    s_and_b32 s56, s62, 1
    s_lshl_b32 s56, s56, 3
    s_add_u32 s56, s56, 12
    s_lshr_b32 s62, s62, 1
    s_lshl_b32 s62, s62, 4
    v_add_u32 v9, s56, v4
    v_and_b32 v9, 15, v9
    v_add_u32 v9, s62, v9
    v_mul_u32_u24 v9, 1152, v9
    v_add_u32 v9, v9, v6
    v_subrev_u32 v210, 2048, v9
    s_lshl_b32 s59, s63, 10
    s_add_u32 s59, s59, 16384
    s_waitcnt lgkmcnt(0)
    s_add_u32 s28, s4, s46
    s_addc_u32 s29, s5, 0
    s_mov_b32 s30, 221184
    s_mov_b32 s31, 0x20000
    s_add_u32 s32, s10, s47
    s_addc_u32 s33, s11, 0
    s_sub_u32 s34, 4718592, s47
    s_mov_b32 s35, 0x20000
    s_add_u32 s20, s6, s45
    s_addc_u32 s21, s7, 0
    s_mov_b32 s22, 262144
    s_mov_b32 s23, 0x20000
    s_add_u32 s24, s8, s45
    s_addc_u32 s25, s9, 0
    s_mov_b32 s26, 262144
    s_mov_b32 s27, 0x20000
    s_add_u32 s36, s18, s48
    s_addc_u32 s37, s19, 0
    s_mov_b32 s38, 1572864
    s_mov_b32 s39, 0x20000
    s_add_u32 s92, s18, 50331648
    s_addc_u32 s93, s19, 0
    s_mov_b32 s94, 33792
    s_mov_b32 s95, 0x20000
    s_lshl_b32 s90, s40, 5
    s_add_u32 s90, s90, s41
    s_lshl_b32 s90, s90, 7
    s_lshl_b32 s96, s40, 7
    s_add_u32 s96, s96, 32768
    s_add_u32 m0, s60, 122880
    s_add_u32 s61, s57, 128
    buffer_load_dwordx4 v211, s[32:35], s58 offen offset:0  lds
    buffer_load_dwordx4 v212, s[32:35], s58 offen offset:1024  lds
    s_add_u32 m0, s59, 122880
    s_add_u32 s58, s58, 524288
    buffer_load_dwordx4 v208, s[28:31], s57 offen offset:0  lds
    buffer_load_dwordx4 v209, s[28:31], s57 offen offset:1024  lds
    buffer_load_dwordx4 v210, s[28:31], s57 offen offset:2048  lds
    s_mov_b32 s57, s100
    s_mov_b32 s58, s101
    v_lshl_add_u32 v9, v4, 8, v6
    s_lshl_b32 s46, s43, 12
    s_lshl_b32 s47, s54, 13
    s_add_u32 s46, s46, s47
    s_add_u32 s45, s55, s46
    v_add_u32 v255, s45, v9
    s_lshl_b32 s47, s44, 10
    s_add_u32 s52, s46, s47
    s_add_u32 m0, s60, 0
    s_add_u32 s61, s57, 128
    buffer_load_dwordx4 v211, s[32:35], s58 offen offset:0  lds
    buffer_load_dwordx4 v212, s[32:35], s58 offen offset:1024  lds
    s_add_u32 m0, s59, 0
    s_add_u32 s58, s58, 524288
    buffer_load_dwordx4 v208, s[28:31], s57 offen offset:0  lds
    buffer_load_dwordx4 v209, s[28:31], s57 offen offset:1024  lds
    buffer_load_dwordx4 v210, s[28:31], s57 offen offset:2048  lds
    s_cmp_eq_u32 s61, 1152
    s_cselect_b32 s57, 128, s61
    s_cselect_b32 s58, 524288, s58
    v_lshrrev_b32 v10, 4, v0
    v_and_b32 v6, 15, v0
    v_lshrrev_b32 v7, 2, v6
    v_and_b32 v8, 1, v10
    v_lshl_add_u32 v5, v8, 2, v7
    v_lshlrev_b32 v5, 6, v5
    v_lshl_add_u32 v5, v8, 5, v5
    v_lshl_add_u32 v5, v3, 3, v5
    v_lshrrev_b32 v9, 1, v10
    v_lshl_add_u32 v5, v9, 12, v5
    s_lshl_b32 s45, s54, 11
    v_add_u32 v215, s45, v5
    v_add_u32 v216, 81920, v215
    v_xor_b32 v217, 32, v215
    v_xor_b32 v218, 32, v216
    v_add_u32 v5, 4, v6
    v_bfe_u32 v11, v5, 3, 1
    v_and_b32 v12, 7, v5
    v_lshrrev_b32 v13, 2, v12
    v_lshlrev_b32 v13, 1, v13
    v_lshlrev_b32 v14, 6, v12
    v_xor_b32 v15, v13, v10
    v_lshl_add_u32 v15, v15, 4, v14
    s_mul_i32 s46, s53, 6144
    s_add_u32 s46, s46, 16384
    v_lshl_add_u32 v5, v11, 10, v15
    v_add_u32 v213, s46, v5
    v_add_u32 v214, 81920, v213
    v_lshl_add_u32 v15, v11, 11, v15
    v_lshl_add_u32 v14, v11, 11, v14
    s_lshl_b32 s47, s54, 13
    v_add_u32 v248, s47, v15
    v_add_u32 v248, 16384, v248
    s_mul_i32 s46, s53, 12288
    s_add_u32 s46, s46, 114688
    v_add_u32 v221, s46, v15
    v_xor_b32 v15, v13, v9
    v_lshl_add_u32 v15, v15, 4, v14
    v_lshl_add_u32 v15, v8, 3, v15
    s_lshl_b32 s45, s54, 10
    s_add_u32 s46, s46, s45
    v_add_u32 v219, s46, v15
    v_xor_b32 v220, 32, v219
    v_add_u32 v5, 1, v10
    v_bfe_u32 v11, v5, 1, 1
    v_and_b32 v12, 1, v5
    v_lshl_add_u32 v13, v12, 2, v7
    v_lshlrev_b32 v13, 6, v13
    v_lshl_add_u32 v13, v12, 5, v13
    v_lshl_add_u32 v13, v3, 3, v13
    v_lshl_add_u32 v13, v11, 11, v13
    s_add_u32 s47, s47, 49152
    v_add_u32 v249, s47, v13
    v_xor_b32 v250, 32, v249
    v_lshlrev_b32 v254, 4, v0
    v_add_u32 v244, s52, v254
    v_add_u32 v245, 65536, v244
    v_add_u32 v246, 131072, v244
    s_mov_b32 s48, 0x3e0293ee
    s_mov_b32 s50, 4294836224
    s_mov_b32 s51, 32768
    s_mov_b32 s46, 49152
    s_waitcnt vmcnt(5)
    s_barrier
    ds_read_b128 v[112:115], v214 offset:40960
    ds_read_b128 v[116:119], v214 offset:43008
    ds_read_b128 v[120:123], v214 offset:45056
    ds_read_b64_tr_b16 v[96:97], v216 offset:40960
    ds_read_b64_tr_b16 v[98:99], v216 offset:49152
    ds_read_b64_tr_b16 v[100:101], v218 offset:40960
    ds_read_b64_tr_b16 v[102:103], v218 offset:49152
    ds_read_b64_tr_b16 v[104:105], v216 offset:41472
    ds_read_b64_tr_b16 v[106:107], v216 offset:49664
    ds_read_b64_tr_b16 v[108:109], v218 offset:41472
    ds_read_b64_tr_b16 v[110:111], v218 offset:49664
    ds_read_b128 v[140:143], v214 offset:41472
    ds_read_b128 v[144:147], v214 offset:43520
    ds_read_b128 v[148:151], v214 offset:45568
    ds_read_b64_tr_b16 v[124:125], v216 offset:41984
    ds_read_b64_tr_b16 v[126:127], v216 offset:50176
    ds_read_b64_tr_b16 v[128:129], v218 offset:41984
    ds_read_b64_tr_b16 v[130:131], v218 offset:50176
    ds_read_b64_tr_b16 v[132:133], v216 offset:42496
    ds_read_b64_tr_b16 v[134:135], v216 offset:50688
    ds_read_b64_tr_b16 v[136:137], v218 offset:42496
    ds_read_b64_tr_b16 v[138:139], v218 offset:50688
    s_add_u32 m0, s60, 40960
    s_add_u32 s61, s57, 128
    buffer_load_dwordx4 v211, s[32:35], s58 offen offset:0  lds
    buffer_load_dwordx4 v212, s[32:35], s58 offen offset:1024  lds
    s_add_u32 m0, s59, 40960
    s_add_u32 s58, s58, 524288
    buffer_load_dwordx4 v208, s[28:31], s57 offen offset:0  lds
    buffer_load_dwordx4 v209, s[28:31], s57 offen offset:1024  lds
    buffer_load_dwordx4 v210, s[28:31], s57 offen offset:2048  lds
    s_cmp_eq_u32 s61, 1152
    s_cselect_b32 s57, 128, s61
    s_cselect_b32 s58, 524288, s58
    s_waitcnt lgkmcnt(0)
    s_waitcnt vmcnt(5)
    s_barrier
    v_mfma_f32_16x16x32_bf16 v[0:3], v[96:99], v[112:115], 0
    ds_read_b128 v[168:171], v213 offset:0
    ds_read_b128 v[172:175], v213 offset:2048
    v_mfma_f32_16x16x32_bf16 v[4:7], v[96:99], v[116:119], 0
    s_add_u32 m0, s60, 81920
    s_add_u32 s61, s57, 128
    buffer_load_dwordx4 v211, s[32:35], s58 offen  lds
    ds_read_b128 v[176:179], v213 offset:4096
    v_mfma_f32_16x16x32_bf16 v[8:11], v[96:99], v[120:123], 0
    ds_read_b64_tr_b16 v[152:153], v215 offset:0
    buffer_load_dwordx4 v212, s[32:35], s58 offen offset:1024  lds
    s_add_u32 m0, s59, 81920
    s_add_u32 s58, s58, 524288
    v_mfma_f32_16x16x32_bf16 v[12:15], v[100:103], v[112:115], 0
    ds_read_b64_tr_b16 v[154:155], v215 offset:8192
    ds_read_b64_tr_b16 v[156:157], v217 offset:0
    v_mfma_f32_16x16x32_bf16 v[16:19], v[100:103], v[116:119], 0
    buffer_load_dwordx4 v208, s[28:31], s57 offen offset:0  lds
    ds_read_b64_tr_b16 v[158:159], v217 offset:8192
    v_mfma_f32_16x16x32_bf16 v[20:23], v[100:103], v[120:123], 0
    ds_read_b64_tr_b16 v[160:161], v215 offset:512
    buffer_load_dwordx4 v209, s[28:31], s57 offen offset:1024  lds
    v_mfma_f32_16x16x32_bf16 v[24:27], v[104:107], v[112:115], 0
    ds_read_b64_tr_b16 v[162:163], v215 offset:8704
    v_mfma_f32_16x16x32_bf16 v[28:31], v[104:107], v[116:119], 0
    ds_read_b64_tr_b16 v[164:165], v217 offset:512
    buffer_load_dwordx4 v210, s[28:31], s57 offen offset:2048  lds
    s_cmp_eq_u32 s61, 1152
    s_cselect_b32 s57, 128, s61
    s_cselect_b32 s58, 524288, s58
    v_mfma_f32_16x16x32_bf16 v[32:35], v[104:107], v[120:123], 0
    ds_read_b64_tr_b16 v[166:167], v217 offset:8704
    ds_read_b128 v[196:199], v213 offset:512
    v_mfma_f32_16x16x32_bf16 v[36:39], v[108:111], v[112:115], 0
    s_add_u32 m0, s60, 122880
    s_add_u32 s61, s57, 128
    buffer_load_dwordx4 v211, s[32:35], s58 offen  lds
    ds_read_b128 v[200:203], v213 offset:2560
    v_mfma_f32_16x16x32_bf16 v[40:43], v[108:111], v[116:119], 0
    ds_read_b128 v[204:207], v213 offset:4608
    buffer_load_dwordx4 v212, s[32:35], s58 offen offset:1024  lds
    s_add_u32 m0, s59, 122880
    s_add_u32 s58, s58, 524288
    v_mfma_f32_16x16x32_bf16 v[44:47], v[108:111], v[120:123], 0
    ds_read_b64_tr_b16 v[180:181], v215 offset:1024
    ds_read_b64_tr_b16 v[182:183], v215 offset:9216
    v_mfma_f32_16x16x32_bf16 v[0:3], v[124:127], v[140:143], v[0:3]
    buffer_load_dwordx4 v208, s[28:31], s57 offen offset:0  lds
    ds_read_b64_tr_b16 v[184:185], v217 offset:1024
    v_mfma_f32_16x16x32_bf16 v[4:7], v[124:127], v[144:147], v[4:7]
    ds_read_b64_tr_b16 v[186:187], v217 offset:9216
    v_mfma_f32_16x16x32_bf16 v[8:11], v[124:127], v[148:151], v[8:11]
    buffer_load_dwordx4 v209, s[28:31], s57 offen offset:1024  lds
    ds_read_b64_tr_b16 v[188:189], v215 offset:1536
    v_mfma_f32_16x16x32_bf16 v[12:15], v[128:131], v[140:143], v[12:15]
    ds_read_b64_tr_b16 v[190:191], v215 offset:9728
    buffer_load_dwordx4 v210, s[28:31], s57 offen offset:2048  lds
    s_cmp_eq_u32 s61, 1152
    s_cselect_b32 s57, 128, s61
    s_cselect_b32 s58, 524288, s58
    v_mfma_f32_16x16x32_bf16 v[16:19], v[128:131], v[144:147], v[16:19]
    ds_read_b64_tr_b16 v[192:193], v217 offset:1536
    ds_read_b64_tr_b16 v[194:195], v217 offset:9728
    v_mfma_f32_16x16x32_bf16 v[20:23], v[128:131], v[148:151], v[20:23]
    v_mov_b32 v48, 0
    v_mov_b32 v49, 0
    v_mfma_f32_16x16x32_bf16 v[24:27], v[132:135], v[140:143], v[24:27]
    v_mov_b32 v50, 0
    v_mov_b32 v51, 0
    v_mfma_f32_16x16x32_bf16 v[28:31], v[132:135], v[144:147], v[28:31]
    v_mov_b32 v52, 0
    v_mov_b32 v53, 0
    v_mfma_f32_16x16x32_bf16 v[32:35], v[132:135], v[148:151], v[32:35]
    v_mov_b32 v54, 0
    v_mfma_f32_16x16x32_bf16 v[36:39], v[136:139], v[140:143], v[36:39]
    v_mfma_f32_16x16x32_bf16 v[40:43], v[136:139], v[144:147], v[40:43]
    v_mfma_f32_16x16x32_bf16 v[44:47], v[136:139], v[148:151], v[44:47]
    s_waitcnt lgkmcnt(0)
    s_waitcnt vmcnt(10)
    s_barrier
    v_mfma_f32_16x16x32_bf16 v[0:3], v[152:155], v[168:171], v[0:3]
    ds_read_b128 v[112:115], v213 offset:40960
    ds_read_b128 v[116:119], v213 offset:43008
    v_mfma_f32_16x16x32_bf16 v[4:7], v[152:155], v[172:175], v[4:7]
    ds_read_b128 v[120:123], v213 offset:45056
    ds_read_b64_tr_b16 v[96:97], v215 offset:40960
    v_mfma_f32_16x16x32_bf16 v[8:11], v[152:155], v[176:179], v[8:11]
    s_add_u32 m0, s60, 0
    s_add_u32 s61, s57, 128
    buffer_load_dwordx4 v211, s[32:35], s58 offen  lds
    v_mfma_f32_16x16x32_bf16 v[12:15], v[156:159], v[168:171], v[12:15]
    ds_read_b64_tr_b16 v[98:99], v215 offset:49152
    ds_read_b64_tr_b16 v[100:101], v217 offset:40960
    v_mfma_f32_16x16x32_bf16 v[16:19], v[156:159], v[172:175], v[16:19]
    ds_read_b64_tr_b16 v[102:103], v217 offset:49152
    ds_read_b64_tr_b16 v[104:105], v215 offset:41472
    v_mfma_f32_16x16x32_bf16 v[20:23], v[156:159], v[176:179], v[20:23]
    buffer_load_dwordx4 v212, s[32:35], s58 offen offset:1024  lds
    s_add_u32 m0, s59, 0
    s_add_u32 s58, s58, 524288
    v_mfma_f32_16x16x32_bf16 v[24:27], v[160:163], v[168:171], v[24:27]
    ds_read_b64_tr_b16 v[106:107], v215 offset:49664
    ds_read_b64_tr_b16 v[108:109], v217 offset:41472
    v_mfma_f32_16x16x32_bf16 v[28:31], v[160:163], v[172:175], v[28:31]
    ds_read_b64_tr_b16 v[110:111], v217 offset:49664
    v_mfma_f32_16x16x32_bf16 v[32:35], v[160:163], v[176:179], v[32:35]
    ds_read_b128 v[140:143], v213 offset:41472
    buffer_load_dwordx4 v208, s[28:31], s57 offen offset:0  lds
    v_mfma_f32_16x16x32_bf16 v[36:39], v[164:167], v[168:171], v[36:39]
    ds_read_b128 v[144:147], v213 offset:43520
    ds_read_b128 v[148:151], v213 offset:45568
    v_mfma_f32_16x16x32_bf16 v[40:43], v[164:167], v[172:175], v[40:43]
    ds_read_b64_tr_b16 v[124:125], v215 offset:41984
    v_mfma_f32_16x16x32_bf16 v[44:47], v[164:167], v[176:179], v[44:47]
    ds_read_b64_tr_b16 v[126:127], v215 offset:50176
    buffer_load_dwordx4 v209, s[28:31], s57 offen offset:1024  lds
    v_mfma_f32_16x16x32_bf16 v[0:3], v[180:183], v[196:199], v[0:3]
    ds_read_b64_tr_b16 v[128:129], v217 offset:41984
    ds_read_b64_tr_b16 v[130:131], v217 offset:50176
    v_mfma_f32_16x16x32_bf16 v[4:7], v[180:183], v[200:203], v[4:7]
    ds_read_b64_tr_b16 v[132:133], v215 offset:42496
    v_mfma_f32_16x16x32_bf16 v[8:11], v[180:183], v[204:207], v[8:11]
    ds_read_b64_tr_b16 v[134:135], v215 offset:50688
    buffer_load_dwordx4 v210, s[28:31], s57 offen offset:2048  lds
    s_cmp_eq_u32 s61, 1152
    s_cselect_b32 s57, 128, s61
    s_cselect_b32 s58, 524288, s58
    v_mfma_f32_16x16x32_bf16 v[12:15], v[184:187], v[196:199], v[12:15]
    ds_read_b64_tr_b16 v[136:137], v217 offset:42496
    v_mfma_f32_16x16x32_bf16 v[16:19], v[184:187], v[200:203], v[16:19]
    ds_read_b64_tr_b16 v[138:139], v217 offset:50688
    v_mov_b32 v55, 0
    v_mfma_f32_16x16x32_bf16 v[20:23], v[184:187], v[204:207], v[20:23]
    v_mov_b32 v56, 0
    v_mov_b32 v57, 0
    v_mfma_f32_16x16x32_bf16 v[24:27], v[188:191], v[196:199], v[24:27]
    v_mov_b32 v58, 0
    v_mfma_f32_16x16x32_bf16 v[28:31], v[188:191], v[200:203], v[28:31]
    v_mov_b32 v59, 0
    v_mov_b32 v60, 0
    v_mfma_f32_16x16x32_bf16 v[32:35], v[188:191], v[204:207], v[32:35]
    v_mov_b32 v61, 0
    v_mfma_f32_16x16x32_bf16 v[36:39], v[192:195], v[196:199], v[36:39]
    v_mfma_f32_16x16x32_bf16 v[40:43], v[192:195], v[200:203], v[40:43]
    v_mfma_f32_16x16x32_bf16 v[44:47], v[192:195], v[204:207], v[44:47]
    s_waitcnt lgkmcnt(0)
    s_waitcnt vmcnt(10)
    s_barrier
    v_mfma_f32_16x16x32_bf16 v[0:3], v[96:99], v[112:115], v[0:3]
    ds_read_b128 v[168:171], v214 offset:0
    ds_read_b128 v[172:175], v214 offset:2048
    v_mfma_f32_16x16x32_bf16 v[4:7], v[96:99], v[116:119], v[4:7]
    ds_read_b128 v[176:179], v214 offset:4096
    ds_read_b64_tr_b16 v[152:153], v216 offset:0
    v_mfma_f32_16x16x32_bf16 v[8:11], v[96:99], v[120:123], v[8:11]
    s_add_u32 m0, s60, 40960
    s_add_u32 s61, s57, 128
    buffer_load_dwordx4 v211, s[32:35], s58 offen  lds
    v_mfma_f32_16x16x32_bf16 v[12:15], v[100:103], v[112:115], v[12:15]
    ds_read_b64_tr_b16 v[154:155], v216 offset:8192
    ds_read_b64_tr_b16 v[156:157], v218 offset:0
    v_mfma_f32_16x16x32_bf16 v[16:19], v[100:103], v[116:119], v[16:19]
    ds_read_b64_tr_b16 v[158:159], v218 offset:8192
    ds_read_b64_tr_b16 v[160:161], v216 offset:512
    v_mfma_f32_16x16x32_bf16 v[20:23], v[100:103], v[120:123], v[20:23]
    buffer_load_dwordx4 v212, s[32:35], s58 offen offset:1024  lds
    s_add_u32 m0, s59, 40960
    s_add_u32 s58, s58, 524288
    v_mfma_f32_16x16x32_bf16 v[24:27], v[104:107], v[112:115], v[24:27]
    ds_read_b64_tr_b16 v[162:163], v216 offset:8704
    ds_read_b64_tr_b16 v[164:165], v218 offset:512
    v_mfma_f32_16x16x32_bf16 v[28:31], v[104:107], v[116:119], v[28:31]
    ds_read_b64_tr_b16 v[166:167], v218 offset:8704
    v_mfma_f32_16x16x32_bf16 v[32:35], v[104:107], v[120:123], v[32:35]
    ds_read_b128 v[196:199], v214 offset:512
    buffer_load_dwordx4 v208, s[28:31], s57 offen offset:0  lds
    v_mfma_f32_16x16x32_bf16 v[36:39], v[108:111], v[112:115], v[36:39]
    ds_read_b128 v[200:203], v214 offset:2560
    ds_read_b128 v[204:207], v214 offset:4608
    v_mfma_f32_16x16x32_bf16 v[40:43], v[108:111], v[116:119], v[40:43]
    ds_read_b64_tr_b16 v[180:181], v216 offset:1024
    v_mfma_f32_16x16x32_bf16 v[44:47], v[108:111], v[120:123], v[44:47]
    ds_read_b64_tr_b16 v[182:183], v216 offset:9216
    buffer_load_dwordx4 v209, s[28:31], s57 offen offset:1024  lds
    v_mfma_f32_16x16x32_bf16 v[0:3], v[124:127], v[140:143], v[0:3]
    ds_read_b64_tr_b16 v[184:185], v218 offset:1024
    ds_read_b64_tr_b16 v[186:187], v218 offset:9216
    v_mfma_f32_16x16x32_bf16 v[4:7], v[124:127], v[144:147], v[4:7]
    ds_read_b64_tr_b16 v[188:189], v216 offset:1536
    v_mfma_f32_16x16x32_bf16 v[8:11], v[124:127], v[148:151], v[8:11]
    ds_read_b64_tr_b16 v[190:191], v216 offset:9728
    buffer_load_dwordx4 v210, s[28:31], s57 offen offset:2048  lds
    s_cmp_eq_u32 s61, 1152
    s_cselect_b32 s57, 128, s61
    s_cselect_b32 s58, 524288, s58
    v_mfma_f32_16x16x32_bf16 v[12:15], v[128:131], v[140:143], v[12:15]
    ds_read_b64_tr_b16 v[192:193], v218 offset:1536
    v_mfma_f32_16x16x32_bf16 v[16:19], v[128:131], v[144:147], v[16:19]
    ds_read_b64_tr_b16 v[194:195], v218 offset:9728
    v_mov_b32 v62, 0
    v_mfma_f32_16x16x32_bf16 v[20:23], v[128:131], v[148:151], v[20:23]
    v_mov_b32 v63, 0
    v_mov_b32 v64, 0
    v_mfma_f32_16x16x32_bf16 v[24:27], v[132:135], v[140:143], v[24:27]
    v_mov_b32 v65, 0
    v_mfma_f32_16x16x32_bf16 v[28:31], v[132:135], v[144:147], v[28:31]
    v_mov_b32 v66, 0
    v_mov_b32 v67, 0
    v_mfma_f32_16x16x32_bf16 v[32:35], v[132:135], v[148:151], v[32:35]
    v_mov_b32 v68, 0
    v_mfma_f32_16x16x32_bf16 v[36:39], v[136:139], v[140:143], v[36:39]
    v_mfma_f32_16x16x32_bf16 v[40:43], v[136:139], v[144:147], v[40:43]
    v_mfma_f32_16x16x32_bf16 v[44:47], v[136:139], v[148:151], v[44:47]
    s_waitcnt lgkmcnt(0)
    s_waitcnt vmcnt(10)
    s_barrier
    v_mfma_f32_16x16x32_bf16 v[0:3], v[152:155], v[168:171], v[0:3]
    ds_read_b128 v[112:115], v214 offset:40960
    ds_read_b128 v[116:119], v214 offset:43008
    v_mfma_f32_16x16x32_bf16 v[4:7], v[152:155], v[172:175], v[4:7]
    ds_read_b128 v[120:123], v214 offset:45056
    ds_read_b64_tr_b16 v[96:97], v216 offset:40960
    v_mfma_f32_16x16x32_bf16 v[8:11], v[152:155], v[176:179], v[8:11]
    s_add_u32 m0, s60, 81920
    s_add_u32 s61, s57, 128
    buffer_load_dwordx4 v211, s[32:35], s58 offen  lds
    v_mfma_f32_16x16x32_bf16 v[12:15], v[156:159], v[168:171], v[12:15]
    ds_read_b64_tr_b16 v[98:99], v216 offset:49152
    ds_read_b64_tr_b16 v[100:101], v218 offset:40960
    v_mfma_f32_16x16x32_bf16 v[16:19], v[156:159], v[172:175], v[16:19]
    ds_read_b64_tr_b16 v[102:103], v218 offset:49152
    ds_read_b64_tr_b16 v[104:105], v216 offset:41472
    v_mfma_f32_16x16x32_bf16 v[20:23], v[156:159], v[176:179], v[20:23]
    buffer_load_dwordx4 v212, s[32:35], s58 offen offset:1024  lds
    s_add_u32 m0, s59, 81920
    s_add_u32 s58, s58, 524288
    v_mfma_f32_16x16x32_bf16 v[24:27], v[160:163], v[168:171], v[24:27]
    ds_read_b64_tr_b16 v[106:107], v216 offset:49664
    ds_read_b64_tr_b16 v[108:109], v218 offset:41472
    v_mfma_f32_16x16x32_bf16 v[28:31], v[160:163], v[172:175], v[28:31]
    ds_read_b64_tr_b16 v[110:111], v218 offset:49664
    v_mfma_f32_16x16x32_bf16 v[32:35], v[160:163], v[176:179], v[32:35]
    ds_read_b128 v[140:143], v214 offset:41472
    buffer_load_dwordx4 v208, s[28:31], s57 offen offset:0  lds
    v_mfma_f32_16x16x32_bf16 v[36:39], v[164:167], v[168:171], v[36:39]
    ds_read_b128 v[144:147], v214 offset:43520
    ds_read_b128 v[148:151], v214 offset:45568
    v_mfma_f32_16x16x32_bf16 v[40:43], v[164:167], v[172:175], v[40:43]
    ds_read_b64_tr_b16 v[124:125], v216 offset:41984
    v_mfma_f32_16x16x32_bf16 v[44:47], v[164:167], v[176:179], v[44:47]
    ds_read_b64_tr_b16 v[126:127], v216 offset:50176
    buffer_load_dwordx4 v209, s[28:31], s57 offen offset:1024  lds
    v_mfma_f32_16x16x32_bf16 v[0:3], v[180:183], v[196:199], v[0:3]
    ds_read_b64_tr_b16 v[128:129], v218 offset:41984
    ds_read_b64_tr_b16 v[130:131], v218 offset:50176
    v_mfma_f32_16x16x32_bf16 v[4:7], v[180:183], v[200:203], v[4:7]
    ds_read_b64_tr_b16 v[132:133], v216 offset:42496
    v_mfma_f32_16x16x32_bf16 v[8:11], v[180:183], v[204:207], v[8:11]
    ds_read_b64_tr_b16 v[134:135], v216 offset:50688
    buffer_load_dwordx4 v210, s[28:31], s57 offen offset:2048  lds
    s_cmp_eq_u32 s61, 1152
    s_cselect_b32 s57, 128, s61
    s_cselect_b32 s58, 524288, s58
    v_mfma_f32_16x16x32_bf16 v[12:15], v[184:187], v[196:199], v[12:15]
    ds_read_b64_tr_b16 v[136:137], v218 offset:42496
    v_mfma_f32_16x16x32_bf16 v[16:19], v[184:187], v[200:203], v[16:19]
    ds_read_b64_tr_b16 v[138:139], v218 offset:50688
    v_mov_b32 v69, 0
    v_mfma_f32_16x16x32_bf16 v[20:23], v[184:187], v[204:207], v[20:23]
    v_mov_b32 v70, 0
    v_mov_b32 v71, 0
    v_mfma_f32_16x16x32_bf16 v[24:27], v[188:191], v[196:199], v[24:27]
    v_mov_b32 v72, 0
    v_mfma_f32_16x16x32_bf16 v[28:31], v[188:191], v[200:203], v[28:31]
    v_mov_b32 v73, 0
    v_mov_b32 v74, 0
    v_mfma_f32_16x16x32_bf16 v[32:35], v[188:191], v[204:207], v[32:35]
    v_mov_b32 v75, 0
    v_mfma_f32_16x16x32_bf16 v[36:39], v[192:195], v[196:199], v[36:39]
    v_mfma_f32_16x16x32_bf16 v[40:43], v[192:195], v[200:203], v[40:43]
    v_mfma_f32_16x16x32_bf16 v[44:47], v[192:195], v[204:207], v[44:47]
    s_waitcnt lgkmcnt(0)
    s_waitcnt vmcnt(10)
    s_barrier
    v_mfma_f32_16x16x32_bf16 v[0:3], v[96:99], v[112:115], v[0:3]
    ds_read_b128 v[168:171], v213 offset:0
    ds_read_b128 v[172:175], v213 offset:2048
    v_mfma_f32_16x16x32_bf16 v[4:7], v[96:99], v[116:119], v[4:7]
    ds_read_b128 v[176:179], v213 offset:4096
    ds_read_b64_tr_b16 v[152:153], v215 offset:0
    v_mfma_f32_16x16x32_bf16 v[8:11], v[96:99], v[120:123], v[8:11]
    s_add_u32 m0, s60, 122880
    s_add_u32 s61, s57, 128
    buffer_load_dwordx4 v211, s[32:35], s58 offen  lds
    v_mfma_f32_16x16x32_bf16 v[12:15], v[100:103], v[112:115], v[12:15]
    ds_read_b64_tr_b16 v[154:155], v215 offset:8192
    ds_read_b64_tr_b16 v[156:157], v217 offset:0
    v_mfma_f32_16x16x32_bf16 v[16:19], v[100:103], v[116:119], v[16:19]
    ds_read_b64_tr_b16 v[158:159], v217 offset:8192
    ds_read_b64_tr_b16 v[160:161], v215 offset:512
    v_mfma_f32_16x16x32_bf16 v[20:23], v[100:103], v[120:123], v[20:23]
    buffer_load_dwordx4 v212, s[32:35], s58 offen offset:1024  lds
    s_add_u32 m0, s59, 122880
    s_add_u32 s58, s58, 524288
    v_mfma_f32_16x16x32_bf16 v[24:27], v[104:107], v[112:115], v[24:27]
    ds_read_b64_tr_b16 v[162:163], v215 offset:8704
    ds_read_b64_tr_b16 v[164:165], v217 offset:512
    v_mfma_f32_16x16x32_bf16 v[28:31], v[104:107], v[116:119], v[28:31]
    ds_read_b64_tr_b16 v[166:167], v217 offset:8704
    v_mfma_f32_16x16x32_bf16 v[32:35], v[104:107], v[120:123], v[32:35]
    ds_read_b128 v[196:199], v213 offset:512
    buffer_load_dwordx4 v208, s[28:31], s57 offen offset:0  lds
    v_mfma_f32_16x16x32_bf16 v[36:39], v[108:111], v[112:115], v[36:39]
    ds_read_b128 v[200:203], v213 offset:2560
    ds_read_b128 v[204:207], v213 offset:4608
    v_mfma_f32_16x16x32_bf16 v[40:43], v[108:111], v[116:119], v[40:43]
    ds_read_b64_tr_b16 v[180:181], v215 offset:1024
    v_mfma_f32_16x16x32_bf16 v[44:47], v[108:111], v[120:123], v[44:47]
    ds_read_b64_tr_b16 v[182:183], v215 offset:9216
    buffer_load_dwordx4 v209, s[28:31], s57 offen offset:1024  lds
    v_mfma_f32_16x16x32_bf16 v[0:3], v[124:127], v[140:143], v[0:3]
    ds_read_b64_tr_b16 v[184:185], v217 offset:1024
    ds_read_b64_tr_b16 v[186:187], v217 offset:9216
    v_mfma_f32_16x16x32_bf16 v[4:7], v[124:127], v[144:147], v[4:7]
    ds_read_b64_tr_b16 v[188:189], v215 offset:1536
    v_mfma_f32_16x16x32_bf16 v[8:11], v[124:127], v[148:151], v[8:11]
    ds_read_b64_tr_b16 v[190:191], v215 offset:9728
    buffer_load_dwordx4 v210, s[28:31], s57 offen offset:2048  lds
    s_cmp_eq_u32 s61, 1152
    s_cselect_b32 s57, 128, s61
    s_cselect_b32 s58, 524288, s58
    v_mfma_f32_16x16x32_bf16 v[12:15], v[128:131], v[140:143], v[12:15]
    ds_read_b64_tr_b16 v[192:193], v217 offset:1536
    v_mfma_f32_16x16x32_bf16 v[16:19], v[128:131], v[144:147], v[16:19]
    ds_read_b64_tr_b16 v[194:195], v217 offset:9728
    v_mov_b32 v76, 0
    v_mfma_f32_16x16x32_bf16 v[20:23], v[128:131], v[148:151], v[20:23]
    v_mov_b32 v77, 0
    v_mov_b32 v78, 0
    v_mfma_f32_16x16x32_bf16 v[24:27], v[132:135], v[140:143], v[24:27]
    v_mov_b32 v79, 0
    v_mfma_f32_16x16x32_bf16 v[28:31], v[132:135], v[144:147], v[28:31]
    v_mov_b32 v80, 0
    v_mov_b32 v81, 0
    v_mfma_f32_16x16x32_bf16 v[32:35], v[132:135], v[148:151], v[32:35]
    v_mov_b32 v82, 0
    v_mfma_f32_16x16x32_bf16 v[36:39], v[136:139], v[140:143], v[36:39]
    v_mfma_f32_16x16x32_bf16 v[40:43], v[136:139], v[144:147], v[40:43]
    v_mfma_f32_16x16x32_bf16 v[44:47], v[136:139], v[148:151], v[44:47]
    s_waitcnt lgkmcnt(0)
    s_waitcnt vmcnt(10)
    s_barrier
    v_mfma_f32_16x16x32_bf16 v[0:3], v[152:155], v[168:171], v[0:3]
    ds_read_b128 v[112:115], v213 offset:40960
    ds_read_b128 v[116:119], v213 offset:43008
    v_mfma_f32_16x16x32_bf16 v[4:7], v[152:155], v[172:175], v[4:7]
    ds_read_b128 v[120:123], v213 offset:45056
    v_mfma_f32_16x16x32_bf16 v[8:11], v[152:155], v[176:179], v[8:11]
    ds_read_b64_tr_b16 v[96:97], v215 offset:40960
    ds_read_b64_tr_b16 v[98:99], v215 offset:49152
    v_mfma_f32_16x16x32_bf16 v[12:15], v[156:159], v[168:171], v[12:15]
    ds_read_b64_tr_b16 v[100:101], v217 offset:40960
    v_mfma_f32_16x16x32_bf16 v[16:19], v[156:159], v[172:175], v[16:19]
    ds_read_b64_tr_b16 v[102:103], v217 offset:49152
    ds_read_b64_tr_b16 v[104:105], v215 offset:41472
    v_mfma_f32_16x16x32_bf16 v[20:23], v[156:159], v[176:179], v[20:23]
    ds_read_b64_tr_b16 v[106:107], v215 offset:49664
    v_mfma_f32_16x16x32_bf16 v[24:27], v[160:163], v[168:171], v[24:27]
    ds_read_b64_tr_b16 v[108:109], v217 offset:41472
    ds_read_b64_tr_b16 v[110:111], v217 offset:49664
    v_mfma_f32_16x16x32_bf16 v[28:31], v[160:163], v[172:175], v[28:31]
    v_mov_b32 v222, 0
    buffer_load_dword v223, v222, s[92:95], s96 offen sc1
    v_mfma_f32_16x16x32_bf16 v[32:35], v[160:163], v[176:179], v[32:35]
    ds_read_b128 v[140:143], v213 offset:41472
    ds_read_b128 v[144:147], v213 offset:43520
    v_mfma_f32_16x16x32_bf16 v[36:39], v[164:167], v[168:171], v[36:39]
    ds_read_b128 v[148:151], v213 offset:45568
    v_mfma_f32_16x16x32_bf16 v[40:43], v[164:167], v[172:175], v[40:43]
    ds_read_b64_tr_b16 v[124:125], v215 offset:41984
    ds_read_b64_tr_b16 v[126:127], v215 offset:50176
    v_mfma_f32_16x16x32_bf16 v[44:47], v[164:167], v[176:179], v[44:47]
    ds_read_b64_tr_b16 v[128:129], v217 offset:41984
    v_mfma_f32_16x16x32_bf16 v[0:3], v[180:183], v[196:199], v[0:3]
    ds_read_b64_tr_b16 v[130:131], v217 offset:50176
    ds_read_b64_tr_b16 v[132:133], v215 offset:42496
    v_mfma_f32_16x16x32_bf16 v[4:7], v[180:183], v[200:203], v[4:7]
    ds_read_b64_tr_b16 v[134:135], v215 offset:50688
    v_mfma_f32_16x16x32_bf16 v[8:11], v[180:183], v[204:207], v[8:11]
    ds_read_b64_tr_b16 v[136:137], v217 offset:42496
    ds_read_b64_tr_b16 v[138:139], v217 offset:50688
    v_mfma_f32_16x16x32_bf16 v[12:15], v[184:187], v[196:199], v[12:15]
    s_add_u32 m0, s52, 16384
    s_mov_b32 s56, 0
    buffer_load_dwordx4 v255, s[20:23], s56 offen nt lds
    buffer_load_dwordx4 v255, s[20:23], s56 offen offset:2048 nt lds
    v_mfma_f32_16x16x32_bf16 v[16:19], v[184:187], v[200:203], v[16:19]
    v_mov_b32 v83, 0
    v_mov_b32 v84, 0
    v_mfma_f32_16x16x32_bf16 v[20:23], v[184:187], v[204:207], v[20:23]
    v_mov_b32 v85, 0
    v_mfma_f32_16x16x32_bf16 v[24:27], v[188:191], v[196:199], v[24:27]
    v_mov_b32 v86, 0
    v_mov_b32 v87, 0
    v_mfma_f32_16x16x32_bf16 v[28:31], v[188:191], v[200:203], v[28:31]
    v_mov_b32 v88, 0
    v_mfma_f32_16x16x32_bf16 v[32:35], v[188:191], v[204:207], v[32:35]
    v_mov_b32 v89, 0
    v_mfma_f32_16x16x32_bf16 v[36:39], v[192:195], v[196:199], v[36:39]
    v_mfma_f32_16x16x32_bf16 v[40:43], v[192:195], v[200:203], v[40:43]
    v_mfma_f32_16x16x32_bf16 v[44:47], v[192:195], v[204:207], v[44:47]
    s_waitcnt lgkmcnt(0)
    s_waitcnt vmcnt(8)
    s_barrier
    v_mfma_f32_16x16x32_bf16 v[0:3], v[96:99], v[112:115], v[0:3]
    ds_read_b128 v[168:171], v214 offset:0
    ds_read_b128 v[172:175], v214 offset:2048
    v_mfma_f32_16x16x32_bf16 v[4:7], v[96:99], v[116:119], v[4:7]
    ds_read_b128 v[176:179], v214 offset:4096
    v_mfma_f32_16x16x32_bf16 v[8:11], v[96:99], v[120:123], v[8:11]
    ds_read_b64_tr_b16 v[152:153], v216 offset:0
    ds_read_b64_tr_b16 v[154:155], v216 offset:8192
    v_mfma_f32_16x16x32_bf16 v[12:15], v[100:103], v[112:115], v[12:15]
    ds_read_b64_tr_b16 v[156:157], v218 offset:0
    v_mfma_f32_16x16x32_bf16 v[16:19], v[100:103], v[116:119], v[16:19]
    ds_read_b64_tr_b16 v[158:159], v218 offset:8192
    ds_read_b64_tr_b16 v[160:161], v216 offset:512
    v_mfma_f32_16x16x32_bf16 v[20:23], v[100:103], v[120:123], v[20:23]
    ds_read_b64_tr_b16 v[162:163], v216 offset:8704
    v_mfma_f32_16x16x32_bf16 v[24:27], v[104:107], v[112:115], v[24:27]
    ds_read_b64_tr_b16 v[164:165], v218 offset:512
    ds_read_b64_tr_b16 v[166:167], v218 offset:8704
    v_mfma_f32_16x16x32_bf16 v[28:31], v[104:107], v[116:119], v[28:31]
    s_add_u32 m0, s52, 32768
    s_mov_b32 s56, 16384
    buffer_load_dwordx4 v255, s[20:23], s56 offen nt lds
    buffer_load_dwordx4 v255, s[20:23], s56 offen offset:2048 nt lds
    v_mfma_f32_16x16x32_bf16 v[32:35], v[104:107], v[120:123], v[32:35]
    ds_read_b128 v[196:199], v214 offset:512
    ds_read_b128 v[200:203], v214 offset:2560
    v_mfma_f32_16x16x32_bf16 v[36:39], v[108:111], v[112:115], v[36:39]
    ds_read_b128 v[204:207], v214 offset:4608
    v_mfma_f32_16x16x32_bf16 v[40:43], v[108:111], v[116:119], v[40:43]
    ds_read_b64_tr_b16 v[180:181], v216 offset:1024
    ds_read_b64_tr_b16 v[182:183], v216 offset:9216
    v_mfma_f32_16x16x32_bf16 v[44:47], v[108:111], v[120:123], v[44:47]
    ds_read_b64_tr_b16 v[184:185], v218 offset:1024
    v_mfma_f32_16x16x32_bf16 v[0:3], v[124:127], v[140:143], v[0:3]
    ds_read_b64_tr_b16 v[186:187], v218 offset:9216
    ds_read_b64_tr_b16 v[188:189], v216 offset:1536
    v_mfma_f32_16x16x32_bf16 v[4:7], v[124:127], v[144:147], v[4:7]
    ds_read_b64_tr_b16 v[190:191], v216 offset:9728
    v_mfma_f32_16x16x32_bf16 v[8:11], v[124:127], v[148:151], v[8:11]
    ds_read_b64_tr_b16 v[192:193], v218 offset:1536
    ds_read_b64_tr_b16 v[194:195], v218 offset:9728
    v_mfma_f32_16x16x32_bf16 v[12:15], v[128:131], v[140:143], v[12:15]
    s_add_u32 m0, s52, 49152
    s_mov_b32 s56, 0
    buffer_load_dwordx4 v255, s[24:27], s56 offen nt lds
    buffer_load_dwordx4 v255, s[24:27], s56 offen offset:2048 nt lds
    v_mfma_f32_16x16x32_bf16 v[16:19], v[128:131], v[144:147], v[16:19]
    v_mov_b32 v90, 0
    v_mov_b32 v91, 0
    v_mfma_f32_16x16x32_bf16 v[20:23], v[128:131], v[148:151], v[20:23]
    v_mov_b32 v92, 0
    v_mfma_f32_16x16x32_bf16 v[24:27], v[132:135], v[140:143], v[24:27]
    v_mov_b32 v93, 0
    v_mov_b32 v94, 0
    v_mfma_f32_16x16x32_bf16 v[28:31], v[132:135], v[144:147], v[28:31]
    v_mov_b32 v95, 0
    v_mfma_f32_16x16x32_bf16 v[32:35], v[132:135], v[148:151], v[32:35]
    v_mov_b32 v251, 0
    v_mfma_f32_16x16x32_bf16 v[36:39], v[136:139], v[140:143], v[36:39]
    v_mfma_f32_16x16x32_bf16 v[40:43], v[136:139], v[144:147], v[40:43]
    v_mfma_f32_16x16x32_bf16 v[44:47], v[136:139], v[148:151], v[44:47]
    s_waitcnt lgkmcnt(0)
    s_waitcnt vmcnt(7)
    s_barrier
    v_mfma_f32_16x16x32_bf16 v[0:3], v[152:155], v[168:171], v[0:3]
    ds_read_b128 v[112:115], v214 offset:40960
    ds_read_b128 v[116:119], v214 offset:43008
    v_mfma_f32_16x16x32_bf16 v[4:7], v[152:155], v[172:175], v[4:7]
    ds_read_b128 v[120:123], v214 offset:45056
    v_mfma_f32_16x16x32_bf16 v[8:11], v[152:155], v[176:179], v[8:11]
    ds_read_b64_tr_b16 v[96:97], v216 offset:40960
    v_mfma_f32_16x16x32_bf16 v[12:15], v[156:159], v[168:171], v[12:15]
    ds_read_b64_tr_b16 v[98:99], v216 offset:49152
    v_mfma_f32_16x16x32_bf16 v[16:19], v[156:159], v[172:175], v[16:19]
    ds_read_b64_tr_b16 v[100:101], v218 offset:40960
    v_mfma_f32_16x16x32_bf16 v[20:23], v[156:159], v[176:179], v[20:23]
    ds_read_b64_tr_b16 v[102:103], v218 offset:49152
    ds_read_b64_tr_b16 v[104:105], v216 offset:41472
    v_mfma_f32_16x16x32_bf16 v[24:27], v[160:163], v[168:171], v[24:27]
    ds_read_b64_tr_b16 v[106:107], v216 offset:49664
    v_mfma_f32_16x16x32_bf16 v[28:31], v[160:163], v[172:175], v[28:31]
    ds_read_b64_tr_b16 v[108:109], v218 offset:41472
    v_mfma_f32_16x16x32_bf16 v[32:35], v[160:163], v[176:179], v[32:35]
    ds_read_b64_tr_b16 v[110:111], v218 offset:49664
    v_mfma_f32_16x16x32_bf16 v[36:39], v[164:167], v[168:171], v[36:39]
    ds_read_b128 v[140:143], v214 offset:41472
    v_mfma_f32_16x16x32_bf16 v[40:43], v[164:167], v[172:175], v[40:43]
    ds_read_b128 v[144:147], v214 offset:43520
    ds_read_b128 v[148:151], v214 offset:45568
    v_mfma_f32_16x16x32_bf16 v[44:47], v[164:167], v[176:179], v[44:47]
    ds_read_b64_tr_b16 v[124:125], v216 offset:41984
    v_mfma_f32_16x16x32_bf16 v[0:3], v[180:183], v[196:199], v[0:3]
    ds_read_b64_tr_b16 v[126:127], v216 offset:50176
    v_mfma_f32_16x16x32_bf16 v[4:7], v[180:183], v[200:203], v[4:7]
    ds_read_b64_tr_b16 v[128:129], v218 offset:41984
    v_mfma_f32_16x16x32_bf16 v[8:11], v[180:183], v[204:207], v[8:11]
    ds_read_b64_tr_b16 v[130:131], v218 offset:50176
    v_mfma_f32_16x16x32_bf16 v[12:15], v[184:187], v[196:199], v[12:15]
    ds_read_b64_tr_b16 v[132:133], v216 offset:42496
    ds_read_b64_tr_b16 v[134:135], v216 offset:50688
    v_mfma_f32_16x16x32_bf16 v[16:19], v[184:187], v[200:203], v[16:19]
    ds_read_b64_tr_b16 v[136:137], v218 offset:42496
    v_mfma_f32_16x16x32_bf16 v[20:23], v[184:187], v[204:207], v[20:23]
    ds_read_b64_tr_b16 v[138:139], v218 offset:50688
    v_mfma_f32_16x16x32_bf16 v[24:27], v[188:191], v[196:199], v[24:27]
    s_add_u32 m0, s52, 65536
    s_mov_b32 s56, 32768
    buffer_load_dwordx4 v255, s[20:23], s56 offen nt lds
    buffer_load_dwordx4 v255, s[20:23], s56 offen offset:2048 nt lds
    v_mfma_f32_16x16x32_bf16 v[28:31], v[188:191], v[200:203], v[28:31]
    v_mov_b32 v252, 0
    v_mfma_f32_16x16x32_bf16 v[32:35], v[188:191], v[204:207], v[32:35]
    v_mov_b32 v253, 0
    v_mfma_f32_16x16x32_bf16 v[36:39], v[192:195], v[196:199], v[36:39]
    v_mfma_f32_16x16x32_bf16 v[40:43], v[192:195], v[200:203], v[40:43]
    v_mfma_f32_16x16x32_bf16 v[44:47], v[192:195], v[204:207], v[44:47]
    s_waitcnt lgkmcnt(0)
    s_barrier
    s_add_u32 m0, s52, 81920
    s_mov_b32 s56, 16384
    buffer_load_dwordx4 v255, s[24:27], s56 offen nt lds
    buffer_load_dwordx4 v255, s[24:27], s56 offen offset:2048 nt lds
    v_mfma_f32_16x16x32_bf16 v[0:3], v[96:99], v[112:115], v[0:3]
    v_mfma_f32_16x16x32_bf16 v[0:3], v[124:127], v[140:143], v[0:3]
    v_mfma_f32_16x16x32_bf16 v[4:7], v[96:99], v[116:119], v[4:7]
    v_mfma_f32_16x16x32_bf16 v[4:7], v[124:127], v[144:147], v[4:7]
    v_mfma_f32_16x16x32_bf16 v[8:11], v[96:99], v[120:123], v[8:11]
    v_mfma_f32_16x16x32_bf16 v[8:11], v[124:127], v[148:151], v[8:11]
    s_nop 2
    v_mfma_f32_16x16x32_bf16 v[12:15], v[100:103], v[112:115], v[12:15]
    v_mul_f32 v0, s48, v0
    v_mul_f32 v1, s48, v1
    v_mul_f32 v2, s48, v2
    v_mfma_f32_16x16x32_bf16 v[12:15], v[128:131], v[140:143], v[12:15]
    v_mul_f32 v3, s48, v3
    v_cvt_pk_bf16_f32 v0, v0, v1
    v_cvt_pk_bf16_f32 v1, v2, v3
    ds_write_b64 v219, v[0:1] offset:0
    v_mfma_f32_16x16x32_bf16 v[16:19], v[100:103], v[116:119], v[16:19]
    v_mul_f32 v4, s48, v4
    v_mul_f32 v5, s48, v5
    v_mul_f32 v6, s48, v6
    v_mfma_f32_16x16x32_bf16 v[16:19], v[128:131], v[144:147], v[16:19]
    v_mul_f32 v7, s48, v7
    v_cvt_pk_bf16_f32 v4, v4, v5
    v_cvt_pk_bf16_f32 v5, v6, v7
    ds_write_b64 v219, v[4:5] offset:4096
    v_mfma_f32_16x16x32_bf16 v[20:23], v[100:103], v[120:123], v[20:23]
    v_mul_f32 v8, s48, v8
    v_mul_f32 v9, s48, v9
    v_mul_f32 v10, s48, v10
    v_mfma_f32_16x16x32_bf16 v[20:23], v[128:131], v[148:151], v[20:23]
    v_mul_f32 v11, s48, v11
    v_cvt_pk_bf16_f32 v8, v8, v9
    v_cvt_pk_bf16_f32 v9, v10, v11
    ds_write_b64 v219, v[8:9] offset:8192
    v_mfma_f32_16x16x32_bf16 v[24:27], v[104:107], v[112:115], v[24:27]
    v_mul_f32 v12, s48, v12
    v_mul_f32 v13, s48, v13
    v_mul_f32 v14, s48, v14
    v_mfma_f32_16x16x32_bf16 v[24:27], v[132:135], v[140:143], v[24:27]
    v_mul_f32 v15, s48, v15
    v_cvt_pk_bf16_f32 v12, v12, v13
    v_cvt_pk_bf16_f32 v13, v14, v15
    ds_write_b64 v220, v[12:13] offset:0
    v_mfma_f32_16x16x32_bf16 v[28:31], v[104:107], v[116:119], v[28:31]
    v_mul_f32 v16, s48, v16
    v_mul_f32 v17, s48, v17
    v_mul_f32 v18, s48, v18
    v_mfma_f32_16x16x32_bf16 v[28:31], v[132:135], v[144:147], v[28:31]
    v_mul_f32 v19, s48, v19
    v_cvt_pk_bf16_f32 v16, v16, v17
    v_cvt_pk_bf16_f32 v17, v18, v19
    ds_write_b64 v220, v[16:17] offset:4096
    v_mfma_f32_16x16x32_bf16 v[32:35], v[104:107], v[120:123], v[32:35]
    v_mul_f32 v20, s48, v20
    v_mul_f32 v21, s48, v21
    v_mul_f32 v22, s48, v22
    v_mfma_f32_16x16x32_bf16 v[32:35], v[132:135], v[148:151], v[32:35]
    v_mul_f32 v23, s48, v23
    v_cvt_pk_bf16_f32 v20, v20, v21
    v_cvt_pk_bf16_f32 v21, v22, v23
    ds_write_b64 v220, v[20:21] offset:8192
    v_mfma_f32_16x16x32_bf16 v[36:39], v[108:111], v[112:115], v[36:39]
    v_mul_f32 v24, s48, v24
    v_mul_f32 v25, s48, v25
    v_mul_f32 v26, s48, v26
    v_mfma_f32_16x16x32_bf16 v[36:39], v[136:139], v[140:143], v[36:39]
    v_mul_f32 v27, s48, v27
    v_cvt_pk_bf16_f32 v24, v24, v25
    v_cvt_pk_bf16_f32 v25, v26, v27
    ds_write_b64 v219, v[24:25] offset:512
    v_mfma_f32_16x16x32_bf16 v[40:43], v[108:111], v[116:119], v[40:43]
    v_mul_f32 v28, s48, v28
    v_mul_f32 v29, s48, v29
    v_mul_f32 v30, s48, v30
    v_mfma_f32_16x16x32_bf16 v[40:43], v[136:139], v[144:147], v[40:43]
    v_mul_f32 v31, s48, v31
    v_cvt_pk_bf16_f32 v28, v28, v29
    v_cvt_pk_bf16_f32 v29, v30, v31
    ds_write_b64 v219, v[28:29] offset:4608
    v_mfma_f32_16x16x32_bf16 v[44:47], v[108:111], v[120:123], v[44:47]
    v_mul_f32 v32, s48, v32
    v_mul_f32 v33, s48, v33
    v_mul_f32 v34, s48, v34
    v_mfma_f32_16x16x32_bf16 v[44:47], v[136:139], v[148:151], v[44:47]
    v_mul_f32 v35, s48, v35
    v_cvt_pk_bf16_f32 v32, v32, v33
    v_cvt_pk_bf16_f32 v33, v34, v35
    ds_write_b64 v219, v[32:33] offset:8704
    v_mul_f32 v36, s48, v36
    v_mul_f32 v37, s48, v37
    v_mul_f32 v38, s48, v38
    v_mul_f32 v39, s48, v39
    v_cvt_pk_bf16_f32 v36, v36, v37
    v_cvt_pk_bf16_f32 v37, v38, v39
    ds_write_b64 v220, v[36:37] offset:512
    v_mul_f32 v40, s48, v40
    v_mul_f32 v41, s48, v41
    v_mul_f32 v42, s48, v42
    v_mul_f32 v43, s48, v43
    v_cvt_pk_bf16_f32 v40, v40, v41
    v_cvt_pk_bf16_f32 v41, v42, v43
    ds_write_b64 v220, v[40:41] offset:4608
    s_nop 0
    v_mul_f32 v44, s48, v44
    v_mul_f32 v45, s48, v45
    v_mul_f32 v46, s48, v46
    v_mul_f32 v47, s48, v47
    v_cvt_pk_bf16_f32 v44, v44, v45
    v_cvt_pk_bf16_f32 v45, v46, v47
    ds_write_b64 v220, v[44:45] offset:8704
    s_waitcnt lgkmcnt(0)
    s_waitcnt vmcnt(6)
    v_readfirstlane_b32 s97, v223
    s_nop 0
    s_mul_i32 s97, s97, 0x9e3779b1
    s_add_u32 s97, s97, 0x7f4a7c15
    s_xor_b32 s98, s97, 0x80000000
    s_barrier
    s_add_u32 m0, s52, 98304
    s_mov_b32 s56, 49152
    buffer_load_dwordx4 v255, s[20:23], s56 offen nt lds
    buffer_load_dwordx4 v255, s[20:23], s56 offen offset:2048 nt lds
    ds_read_b128 v[96:99], v221 offset:0
    ds_read_b128 v[100:103], v221 offset:4096
    ds_read_b128 v[104:107], v221 offset:8192
    ds_read_b128 v[108:111], v221 offset:512
    ds_read_b128 v[112:115], v221 offset:4608
    ds_read_b128 v[116:119], v221 offset:8704
    ds_read_b128 v[120:123], v221 offset:1024
    ds_read_b128 v[124:127], v221 offset:5120
    ds_read_b128 v[128:131], v221 offset:9216
    ds_read_b128 v[132:135], v221 offset:1536
    ds_read_b128 v[136:139], v221 offset:5632
    ds_read_b128 v[140:143], v221 offset:9728
    ds_read_b128 v[192:195], v248 offset:0
    ds_read_b128 v[196:199], v248 offset:512
    ds_read_b128 v[200:203], v248 offset:1024
    ds_read_b128 v[204:207], v248 offset:1536
    s_add_u32 s57, s52, 131072
    s_add_u32 s58, s52, 147456
    s_mov_b32 s59, 65536
    s_mov_b32 s60, 49152
    s_add_u32 s61, s52, 131072
    v_mov_b32 v247, 0x45000000
    s_lshr_b32 s55, s41, 3
    s_mul_i32 s55, s55, 1179648
    s_and_b32 s56, s41, 3
    s_mul_i32 s62, s56, 288
    s_add_u32 s55, s55, s62
    s_and_b32 s62, s41, 1
    s_lshl_b32 s62, s62, 5
    s_sub_u32 s55, s55, s62
    s_lshl_b32 s56, s56, 1
    s_and_b32 s62, s41, 4
    s_add_u32 s56, s56, s62
    s_and_b32 s62, s40, 3
    s_add_u32 s56, s56, s62
    s_and_b32 s56, s56, 7
    s_mul_i32 s56, s56, 147456
    s_add_u32 s55, s55, s56
    s_mul_i32 s56, s42, 18432
    s_add_u32 s55, s55, s56
    s_add_u32 s28, s12, s55
    s_addc_u32 s29, s13, 0
    s_sub_u32 s30, 4718592, s55
    s_mov_b32 s31, 0x20000
    s_waitcnt lgkmcnt(13)
    s_waitcnt lgkmcnt(2)
    v_mfma_f32_16x16x32_bf16 v[144:147], v[192:195], v[96:99], 0
    v_mov_b32 v0, 0
    v_mov_b32 v1, 0
    v_mfma_f32_16x16x32_bf16 v[148:151], v[192:195], v[100:103], 0
    v_mov_b32 v2, 0
    v_mov_b32 v3, 0
    v_mfma_f32_16x16x32_bf16 v[152:155], v[192:195], v[104:107], 0
    ds_read_b128 v[192:195], v248 offset:4096
    v_mov_b32 v4, 0
    v_mov_b32 v5, 0
    v_mfma_f32_16x16x32_bf16 v[144:147], v[196:199], v[108:111], v[144:147]
    v_mov_b32 v6, 0
    v_mov_b32 v7, 0
    v_mfma_f32_16x16x32_bf16 v[148:151], v[196:199], v[112:115], v[148:151]
    v_mov_b32 v8, 0
    v_mov_b32 v9, 0
    v_mfma_f32_16x16x32_bf16 v[152:155], v[196:199], v[116:119], v[152:155]
    ds_read_b128 v[196:199], v248 offset:4608
    v_mov_b32 v10, 0
    v_mov_b32 v11, 0
    s_waitcnt lgkmcnt(2)
    v_mfma_f32_16x16x32_bf16 v[144:147], v[200:203], v[120:123], v[144:147]
    v_mov_b32 v12, 0
    v_mov_b32 v13, 0
    v_mfma_f32_16x16x32_bf16 v[148:151], v[200:203], v[124:127], v[148:151]
    v_mov_b32 v14, 0
    v_mov_b32 v15, 0
    v_mfma_f32_16x16x32_bf16 v[152:155], v[200:203], v[128:131], v[152:155]
    ds_read_b128 v[200:203], v248 offset:5120
    v_mov_b32 v16, 0
    v_mov_b32 v17, 0
    v_mfma_f32_16x16x32_bf16 v[144:147], v[204:207], v[132:135], v[144:147]
    v_mov_b32 v18, 0
    v_mov_b32 v19, 0
    v_mfma_f32_16x16x32_bf16 v[148:151], v[204:207], v[136:139], v[148:151]
    v_mov_b32 v20, 0
    v_mov_b32 v21, 0
    v_mfma_f32_16x16x32_bf16 v[152:155], v[204:207], v[140:143], v[152:155]
    ds_read_b128 v[204:207], v248 offset:5632
    v_add_u32 v248, 16384, v248
    s_mov_b32 s45, 32768
    v_mov_b32 v22, 0
    v_mov_b32 v23, 0
    s_waitcnt lgkmcnt(2)
    v_mfma_f32_16x16x32_bf16 v[156:159], v[192:195], v[96:99], 0
    v_mov_b32 v24, 0
    v_mov_b32 v25, 0
    v_mfma_f32_16x16x32_bf16 v[160:163], v[192:195], v[100:103], 0
    v_mov_b32 v26, 0
    v_mov_b32 v27, 0
    v_mfma_f32_16x16x32_bf16 v[164:167], v[192:195], v[104:107], 0
    ds_read_b128 v[192:195], v248 offset:0
    v_mov_b32 v28, 0
    v_mov_b32 v29, 0
    v_mfma_f32_16x16x32_bf16 v[156:159], v[196:199], v[108:111], v[156:159]
    v_mov_b32 v30, 0
    v_mov_b32 v31, 0
    v_mfma_f32_16x16x32_bf16 v[160:163], v[196:199], v[112:115], v[160:163]
    v_mov_b32 v32, 0
    v_mov_b32 v33, 0
    v_mfma_f32_16x16x32_bf16 v[164:167], v[196:199], v[116:119], v[164:167]
    ds_read_b128 v[196:199], v248 offset:512
    v_mov_b32 v34, 0
    v_mov_b32 v35, 0
    s_waitcnt lgkmcnt(2)
    v_mfma_f32_16x16x32_bf16 v[156:159], v[200:203], v[120:123], v[156:159]
    v_mov_b32 v36, 0
    v_mov_b32 v37, 0
    v_mfma_f32_16x16x32_bf16 v[160:163], v[200:203], v[124:127], v[160:163]
    v_mov_b32 v38, 0
    v_mov_b32 v39, 0
    v_mfma_f32_16x16x32_bf16 v[164:167], v[200:203], v[128:131], v[164:167]
    ds_read_b128 v[200:203], v248 offset:1024
    v_mov_b32 v40, 0
    v_mov_b32 v41, 0
    v_mfma_f32_16x16x32_bf16 v[156:159], v[204:207], v[132:135], v[156:159]
    v_mov_b32 v42, 0
    v_mov_b32 v43, 0
    v_mfma_f32_16x16x32_bf16 v[160:163], v[204:207], v[136:139], v[160:163]
    v_mov_b32 v44, 0
    v_mov_b32 v45, 0
    v_mfma_f32_16x16x32_bf16 v[164:167], v[204:207], v[140:143], v[164:167]
    ds_read_b128 v[204:207], v248 offset:1536
    v_mov_b32 v46, 0
    v_mov_b32 v47, 0
    s_waitcnt vmcnt(6)
    s_barrier
    s_add_u32 m0, s52, 114688
    s_mov_b32 s56, 32768
    buffer_load_dwordx4 v255, s[24:27], s56 offen nt lds
    buffer_load_dwordx4 v255, s[24:27], s56 offen offset:2048 nt lds
    v_max3_f32 v237, v144, v145, v146
    v_max3_f32 v238, v148, v149, v150
    v_max3_f32 v239, v152, v153, v154
    v_max3_f32 v237, v237, v147, v156
    v_max3_f32 v238, v238, v151, v160
    v_max3_f32 v239, v239, v155, v164
    v_max3_f32 v237, v237, v157, v158
    v_max3_f32 v238, v238, v161, v162
    v_max3_f32 v239, v239, v165, v166
    v_max_f32 v237, v237, v159
    v_max_f32 v238, v238, v163
    v_max_f32 v239, v239, v167
    v_mov_b32 v240, v237
    v_mov_b32 v241, v238
    v_mov_b32 v242, v239
    v_permlane32_swap_b32 v237, v240
    v_permlane32_swap_b32 v238, v241
    v_permlane32_swap_b32 v239, v242
    v_max_f32 v237, v237, v240
    v_max_f32 v238, v238, v241
    v_max_f32 v239, v239, v242
    v_mov_b32 v240, v237
    v_mov_b32 v241, v238
    v_mov_b32 v242, v239
    v_permlane16_swap_b32 v237, v240
    v_permlane16_swap_b32 v238, v241
    v_permlane16_swap_b32 v239, v242
    v_max_f32 v237, v237, v240
    v_max_f32 v238, v238, v241
    v_max_f32 v239, v239, v242
    v_sub_f32 v224, 0, v237
    v_sub_f32 v225, 0, v237
    v_sub_f32 v226, 0, v237
    v_sub_f32 v227, 0, v237
    v_sub_f32 v228, 0, v238
    v_sub_f32 v229, 0, v238
    v_sub_f32 v230, 0, v238
    v_sub_f32 v231, 0, v238
    v_sub_f32 v232, 0, v239
    v_sub_f32 v233, 0, v239
    v_sub_f32 v234, 0, v239
    v_sub_f32 v235, 0, v239
    s_waitcnt lgkmcnt(2)
    v_mfma_f32_16x16x32_bf16 v[168:171], v[192:195], v[96:99], v[224:227]
    v_sub_f32 v144, v144, v237
    v_sub_f32 v145, v145, v237
    v_sub_f32 v146, v146, v237
    v_sub_f32 v147, v147, v237
    v_mfma_f32_16x16x32_bf16 v[172:175], v[192:195], v[100:103], v[228:231]
    v_sub_f32 v148, v148, v238
    v_sub_f32 v149, v149, v238
    v_sub_f32 v150, v150, v238
    v_mfma_f32_16x16x32_bf16 v[176:179], v[192:195], v[104:107], v[232:235]
    ds_read_b128 v[192:195], v248 offset:4096
    v_sub_f32 v151, v151, v238
    v_sub_f32 v152, v152, v239
    v_sub_f32 v153, v153, v239
    v_sub_f32 v154, v154, v239
    v_mfma_f32_16x16x32_bf16 v[168:171], v[196:199], v[108:111], v[168:171]
    v_sub_f32 v155, v155, v239
    v_sub_f32 v156, v156, v237
    v_sub_f32 v157, v157, v237
    v_mfma_f32_16x16x32_bf16 v[172:175], v[196:199], v[112:115], v[172:175]
    v_sub_f32 v158, v158, v237
    v_sub_f32 v159, v159, v237
    v_sub_f32 v160, v160, v238
    v_mfma_f32_16x16x32_bf16 v[176:179], v[196:199], v[116:119], v[176:179]
    ds_read_b128 v[196:199], v248 offset:4608
    v_sub_f32 v161, v161, v238
    v_sub_f32 v162, v162, v238
    v_sub_f32 v163, v163, v238
    v_sub_f32 v164, v164, v239
    s_waitcnt lgkmcnt(2)
    v_mfma_f32_16x16x32_bf16 v[168:171], v[200:203], v[120:123], v[168:171]
    v_sub_f32 v165, v165, v239
    v_sub_f32 v166, v166, v239
    v_sub_f32 v167, v167, v239
    v_mfma_f32_16x16x32_bf16 v[172:175], v[200:203], v[124:127], v[172:175]
    v_exp_f32 v144, v144
    v_exp_f32 v145, v145
    v_exp_f32 v146, v146
    v_mfma_f32_16x16x32_bf16 v[176:179], v[200:203], v[128:131], v[176:179]
    ds_read_b128 v[200:203], v248 offset:5120
    v_add_f32 v244, v144, v145
    v_exp_f32 v147, v147
    v_add_f32 v244, v244, v146
    v_cvt_pk_bf16_f32 v144, v144, v145
    v_mfma_f32_16x16x32_bf16 v[168:171], v[204:207], v[132:135], v[168:171]
    v_add_f32 v244, v244, v147
    v_cvt_pk_bf16_f32 v145, v146, v147
    v_exp_f32 v148, v148
    v_mfma_f32_16x16x32_bf16 v[172:175], v[204:207], v[136:139], v[172:175]
    v_exp_f32 v149, v149
    v_exp_f32 v150, v150
    v_add_f32 v245, v148, v149
    v_exp_f32 v151, v151
    v_mfma_f32_16x16x32_bf16 v[176:179], v[204:207], v[140:143], v[176:179]
    ds_read_b128 v[204:207], v248 offset:5632
    s_cmp_ge_u32 s45, 131072
    s_cselect_b32 s47, s50, s51
    s_add_u32 s45, s45, s47
    v_add_u32 v248, s47, v248
    v_add_f32 v245, v245, v150
    v_cvt_pk_bf16_f32 v148, v148, v149
    v_add_f32 v245, v245, v151
    s_waitcnt lgkmcnt(2)
    v_mfma_f32_16x16x32_bf16 v[180:183], v[192:195], v[96:99], v[224:227]
    v_cvt_pk_bf16_f32 v149, v150, v151
    v_exp_f32 v152, v152
    v_exp_f32 v153, v153
    v_mfma_f32_16x16x32_bf16 v[184:187], v[192:195], v[100:103], v[228:231]
    v_exp_f32 v154, v154
    v_add_f32 v246, v152, v153
    v_exp_f32 v155, v155
    v_add_f32 v246, v246, v154
    v_mfma_f32_16x16x32_bf16 v[188:191], v[192:195], v[104:107], v[232:235]
    ds_read_b64_tr_b16 v[208:209], v249 offset:0
    ds_read_b64_tr_b16 v[210:211], v249 offset:4096
    v_cvt_pk_bf16_f32 v152, v152, v153
    v_add_f32 v246, v246, v155
    v_cvt_pk_bf16_f32 v153, v154, v155
    v_mfma_f32_16x16x32_bf16 v[180:183], v[196:199], v[108:111], v[180:183]
    v_exp_f32 v156, v156
    v_exp_f32 v157, v157
    v_add_f32 v244, v244, v156
    v_mfma_f32_16x16x32_bf16 v[184:187], v[196:199], v[112:115], v[184:187]
    v_exp_f32 v158, v158
    v_add_f32 v244, v244, v157
    v_exp_f32 v159, v159
    v_add_f32 v244, v244, v158
    v_mfma_f32_16x16x32_bf16 v[188:191], v[196:199], v[116:119], v[188:191]
    ds_read_b64_tr_b16 v[212:213], v250 offset:0
    ds_read_b64_tr_b16 v[214:215], v250 offset:4096
    v_cvt_pk_bf16_f32 v146, v156, v157
    v_add_f32 v244, v244, v159
    v_cvt_pk_bf16_f32 v147, v158, v159
    s_waitcnt lgkmcnt(4)
    v_mfma_f32_16x16x32_bf16 v[180:183], v[200:203], v[120:123], v[180:183]
    v_exp_f32 v160, v160
    v_exp_f32 v161, v161
    v_add_f32 v245, v245, v160
    v_exp_f32 v162, v162
    v_mfma_f32_16x16x32_bf16 v[184:187], v[200:203], v[124:127], v[184:187]
    v_add_f32 v245, v245, v161
    v_exp_f32 v163, v163
    v_add_f32 v245, v245, v162
    v_mfma_f32_16x16x32_bf16 v[188:191], v[200:203], v[128:131], v[188:191]
    ds_read_b64_tr_b16 v[216:217], v249 offset:512
    ds_read_b64_tr_b16 v[218:219], v249 offset:4608
    v_cvt_pk_bf16_f32 v150, v160, v161
    v_add_f32 v245, v245, v163
    v_cvt_pk_bf16_f32 v151, v162, v163
    v_mfma_f32_16x16x32_bf16 v[180:183], v[204:207], v[132:135], v[180:183]
    v_exp_f32 v164, v164
    v_exp_f32 v165, v165
    v_add_f32 v246, v246, v164
    v_exp_f32 v166, v166
    v_mfma_f32_16x16x32_bf16 v[184:187], v[204:207], v[136:139], v[184:187]
    v_add_f32 v246, v246, v165
    v_exp_f32 v167, v167
    v_add_f32 v246, v246, v166
    v_mfma_f32_16x16x32_bf16 v[188:191], v[204:207], v[140:143], v[188:191]
    ds_read_b64_tr_b16 v[220:221], v250 offset:512
    ds_read_b64_tr_b16 v[222:223], v250 offset:4608
    v_cvt_pk_bf16_f32 v154, v164, v165
    v_add_f32 v246, v246, v167
    v_cvt_pk_bf16_f32 v155, v166, v167
    s_mov_b32 s44, 0
K1_LOOP:
    s_waitcnt vmcnt(2)
    s_barrier
    s_waitcnt lgkmcnt(4)
    v_mfma_f32_16x16x32_bf16 v[0:3], v[208:211], v[144:147], v[0:3]
    v_mfma_f32_16x16x32_bf16 v[4:7], v[208:211], v[148:151], v[4:7]
    s_cmp_eq_u32 s44, 0
    s_cbranch_scc1 SK1
    s_mov_b32 m0, s58
    s_cmp_ge_u32 s58, s61
    s_cselect_b32 s62, s50, s51
    buffer_load_dwordx4 v255, s[24:27], s60 offen nt lds
SK1:
    v_mfma_f32_16x16x32_bf16 v[8:11], v[208:211], v[152:155], v[8:11]
    ds_read_b64_tr_b16 v[208:209], v249 offset:1024
    ds_read_b64_tr_b16 v[210:211], v249 offset:5120
    v_add_f32 v251, v251, v244
    v_add_f32 v252, v252, v245
    v_mfma_f32_16x16x32_bf16 v[12:15], v[212:215], v[144:147], v[12:15]
    v_add_f32 v253, v253, v246
    v_mfma_f32_16x16x32_bf16 v[16:19], v[212:215], v[148:151], v[16:19]
    v_exp_f32 v168, v168
    v_mfma_f32_16x16x32_bf16 v[20:23], v[212:215], v[152:155], v[20:23]
    ds_read_b64_tr_b16 v[212:213], v250 offset:1024
    ds_read_b64_tr_b16 v[214:215], v250 offset:5120
    v_exp_f32 v169, v169
    s_waitcnt lgkmcnt(4)
    v_mfma_f32_16x16x32_bf16 v[24:27], v[216:219], v[144:147], v[24:27]
    v_exp_f32 v170, v170
    v_add_f32 v244, v168, v169
    v_mfma_f32_16x16x32_bf16 v[28:31], v[216:219], v[148:151], v[28:31]
    v_exp_f32 v171, v171
    v_mfma_f32_16x16x32_bf16 v[32:35], v[216:219], v[152:155], v[32:35]
    ds_read_b64_tr_b16 v[216:217], v249 offset:1536
    ds_read_b64_tr_b16 v[218:219], v249 offset:5632
    v_add_f32 v244, v244, v170
    v_mfma_f32_16x16x32_bf16 v[36:39], v[220:223], v[144:147], v[36:39]
    v_cvt_pk_bf16_f32 v168, v168, v169
    v_mfma_f32_16x16x32_bf16 v[40:43], v[220:223], v[148:151], v[40:43]
    v_add_f32 v244, v244, v171
    v_cvt_pk_bf16_f32 v169, v170, v171
    v_mfma_f32_16x16x32_bf16 v[44:47], v[220:223], v[152:155], v[44:47]
    ds_read_b64_tr_b16 v[220:221], v250 offset:1536
    ds_read_b64_tr_b16 v[222:223], v250 offset:5632
    s_cmp_ge_u32 s46, 131072
    s_cselect_b32 s47, s50, s51
    s_add_u32 s46, s46, s47
    v_add_u32 v249, s47, v249
    v_add_u32 v250, s47, v250
    v_exp_f32 v172, v172
    s_waitcnt lgkmcnt(4)
    v_mfma_f32_16x16x32_bf16 v[48:51], v[208:211], v[144:147], v[48:51]
    v_exp_f32 v173, v173
    v_mfma_f32_16x16x32_bf16 v[52:55], v[208:211], v[148:151], v[52:55]
    s_cmp_eq_u32 s44, 0
    s_cbranch_scc1 SK2
    buffer_load_dwordx4 v255, s[24:27], s60 offen offset:2048 nt lds
    s_add_u32 s58, s58, s62
    s_add_u32 s60, s60, 16384
SK2:
    v_exp_f32 v174, v174
    v_mfma_f32_16x16x32_bf16 v[56:59], v[208:211], v[152:155], v[56:59]
    ds_read_b128 v[192:195], v248 offset:0
    v_add_f32 v245, v172, v173
    v_mfma_f32_16x16x32_bf16 v[60:63], v[212:215], v[144:147], v[60:63]
    v_exp_f32 v175, v175
    v_add_f32 v245, v245, v174
    v_mfma_f32_16x16x32_bf16 v[64:67], v[212:215], v[148:151], v[64:67]
    v_cvt_pk_bf16_f32 v172, v172, v173
    v_mfma_f32_16x16x32_bf16 v[68:71], v[212:215], v[152:155], v[68:71]
    ds_read_b128 v[196:199], v248 offset:512
    v_add_f32 v245, v245, v175
    s_waitcnt lgkmcnt(2)
    v_mfma_f32_16x16x32_bf16 v[72:75], v[216:219], v[144:147], v[72:75]
    v_cvt_pk_bf16_f32 v173, v174, v175
    v_mfma_f32_16x16x32_bf16 v[76:79], v[216:219], v[148:151], v[76:79]
    v_exp_f32 v176, v176
    v_exp_f32 v177, v177
    v_mfma_f32_16x16x32_bf16 v[80:83], v[216:219], v[152:155], v[80:83]
    ds_read_b128 v[200:203], v248 offset:1024
    v_exp_f32 v178, v178
    v_mfma_f32_16x16x32_bf16 v[84:87], v[220:223], v[144:147], v[84:87]
    v_add_f32 v246, v176, v177
    v_mfma_f32_16x16x32_bf16 v[88:91], v[220:223], v[148:151], v[88:91]
    v_exp_f32 v179, v179
    v_mfma_f32_16x16x32_bf16 v[92:95], v[220:223], v[152:155], v[92:95]
    ds_read_b128 v[204:207], v248 offset:1536
    v_add_f32 v246, v246, v178
    s_waitcnt lgkmcnt(2)
    v_mfma_f32_16x16x32_bf16 v[144:147], v[192:195], v[96:99], v[224:227]
    v_cvt_pk_bf16_f32 v176, v176, v177
    v_add_f32 v246, v246, v179
    v_mfma_f32_16x16x32_bf16 v[148:151], v[192:195], v[100:103], v[228:231]
    s_mov_b32 m0, s57
    s_cmp_ge_u32 s57, s61
    s_cselect_b32 s62, s50, s51
    buffer_load_dwordx4 v255, s[20:23], s59 offen nt lds
    v_cvt_pk_bf16_f32 v177, v178, v179
    v_exp_f32 v180, v180
    v_mfma_f32_16x16x32_bf16 v[152:155], v[192:195], v[104:107], v[232:235]
    ds_read_b128 v[192:195], v248 offset:4096
    v_exp_f32 v181, v181
    v_mfma_f32_16x16x32_bf16 v[144:147], v[196:199], v[108:111], v[144:147]
    v_add_f32 v244, v244, v180
    v_exp_f32 v182, v182
    v_mfma_f32_16x16x32_bf16 v[148:151], v[196:199], v[112:115], v[148:151]
    v_add_f32 v244, v244, v181
    v_mfma_f32_16x16x32_bf16 v[152:155], v[196:199], v[116:119], v[152:155]
    ds_read_b128 v[196:199], v248 offset:4608
    v_exp_f32 v183, v183
    v_add_f32 v244, v244, v182
    s_waitcnt lgkmcnt(2)
    v_mfma_f32_16x16x32_bf16 v[144:147], v[200:203], v[120:123], v[144:147]
    v_cvt_pk_bf16_f32 v170, v180, v181
    v_mfma_f32_16x16x32_bf16 v[148:151], v[200:203], v[124:127], v[148:151]
    v_add_f32 v244, v244, v183
    v_cvt_pk_bf16_f32 v171, v182, v183
    v_mfma_f32_16x16x32_bf16 v[152:155], v[200:203], v[128:131], v[152:155]
    ds_read_b128 v[200:203], v248 offset:5120
    v_exp_f32 v184, v184
    v_mfma_f32_16x16x32_bf16 v[144:147], v[204:207], v[132:135], v[144:147]
    v_exp_f32 v185, v185
    v_add_f32 v245, v245, v184
    v_mfma_f32_16x16x32_bf16 v[148:151], v[204:207], v[136:139], v[148:151]
    v_exp_f32 v186, v186
    v_mfma_f32_16x16x32_bf16 v[152:155], v[204:207], v[140:143], v[152:155]
    ds_read_b128 v[204:207], v248 offset:5632
    s_cmp_ge_u32 s45, 131072
    s_cselect_b32 s47, s50, s51
    s_add_u32 s45, s45, s47
    v_add_u32 v248, s47, v248
    v_add_f32 v245, v245, v185
    v_exp_f32 v187, v187
    s_waitcnt lgkmcnt(2)
    v_mfma_f32_16x16x32_bf16 v[156:159], v[192:195], v[96:99], v[224:227]
    v_add_f32 v245, v245, v186
    v_mfma_f32_16x16x32_bf16 v[160:163], v[192:195], v[100:103], v[228:231]
    buffer_load_dwordx4 v255, s[20:23], s59 offen offset:2048 nt lds
    s_add_u32 s57, s57, s62
    s_add_u32 s59, s59, 16384
    v_cvt_pk_bf16_f32 v174, v184, v185
    v_add_f32 v245, v245, v187
    v_mfma_f32_16x16x32_bf16 v[164:167], v[192:195], v[104:107], v[232:235]
    ds_read_b64_tr_b16 v[208:209], v249 offset:0
    ds_read_b64_tr_b16 v[210:211], v249 offset:4096
    v_cvt_pk_bf16_f32 v175, v186, v187
    v_mfma_f32_16x16x32_bf16 v[156:159], v[196:199], v[108:111], v[156:159]
    v_exp_f32 v188, v188
    v_exp_f32 v189, v189
    v_mfma_f32_16x16x32_bf16 v[160:163], v[196:199], v[112:115], v[160:163]
    v_add_f32 v246, v246, v188
    v_mfma_f32_16x16x32_bf16 v[164:167], v[196:199], v[116:119], v[164:167]
    ds_read_b64_tr_b16 v[212:213], v250 offset:0
    ds_read_b64_tr_b16 v[214:215], v250 offset:4096
    v_exp_f32 v190, v190
    v_add_f32 v246, v246, v189
    s_waitcnt lgkmcnt(4)
    v_mfma_f32_16x16x32_bf16 v[156:159], v[200:203], v[120:123], v[156:159]
    v_exp_f32 v191, v191
    v_mfma_f32_16x16x32_bf16 v[160:163], v[200:203], v[124:127], v[160:163]
    v_add_f32 v246, v246, v190
    v_cvt_pk_bf16_f32 v178, v188, v189
    v_mfma_f32_16x16x32_bf16 v[164:167], v[200:203], v[128:131], v[164:167]
    ds_read_b64_tr_b16 v[216:217], v249 offset:512
    ds_read_b64_tr_b16 v[218:219], v249 offset:4608
    v_add_f32 v246, v246, v191
    v_mfma_f32_16x16x32_bf16 v[156:159], v[204:207], v[132:135], v[156:159]
    v_cvt_pk_bf16_f32 v179, v190, v191
    v_max3_f32 v236, v244, v245, v246
    v_mfma_f32_16x16x32_bf16 v[160:163], v[204:207], v[136:139], v[160:163]
    v_cmp_nle_f32 vcc, v236, v247
    v_mfma_f32_16x16x32_bf16 v[164:167], v[204:207], v[140:143], v[164:167]
    ds_read_b64_tr_b16 v[220:221], v250 offset:512
    ds_read_b64_tr_b16 v[222:223], v250 offset:4608
    s_cbranch_vccnz P2_RARE
P2_JOIN:
    s_waitcnt vmcnt(2)
    s_barrier
    s_waitcnt lgkmcnt(4)
    v_mfma_f32_16x16x32_bf16 v[0:3], v[208:211], v[168:171], v[0:3]
    v_mfma_f32_16x16x32_bf16 v[4:7], v[208:211], v[172:175], v[4:7]
    s_mov_b32 m0, s58
    s_cmp_ge_u32 s58, s61
    s_cselect_b32 s62, s50, s51
    buffer_load_dwordx4 v255, s[24:27], s60 offen nt lds
    v_mfma_f32_16x16x32_bf16 v[8:11], v[208:211], v[176:179], v[8:11]
    ds_read_b64_tr_b16 v[208:209], v249 offset:1024
    ds_read_b64_tr_b16 v[210:211], v249 offset:5120
    v_add_f32 v251, v251, v244
    v_add_f32 v252, v252, v245
    v_mfma_f32_16x16x32_bf16 v[12:15], v[212:215], v[168:171], v[12:15]
    v_add_f32 v253, v253, v246
    v_mfma_f32_16x16x32_bf16 v[16:19], v[212:215], v[172:175], v[16:19]
    v_exp_f32 v144, v144
    v_mfma_f32_16x16x32_bf16 v[20:23], v[212:215], v[176:179], v[20:23]
    ds_read_b64_tr_b16 v[212:213], v250 offset:1024
    ds_read_b64_tr_b16 v[214:215], v250 offset:5120
    v_exp_f32 v145, v145
    s_waitcnt lgkmcnt(4)
    v_mfma_f32_16x16x32_bf16 v[24:27], v[216:219], v[168:171], v[24:27]
    v_exp_f32 v146, v146
    v_add_f32 v244, v144, v145
    v_mfma_f32_16x16x32_bf16 v[28:31], v[216:219], v[172:175], v[28:31]
    v_exp_f32 v147, v147
    v_mfma_f32_16x16x32_bf16 v[32:35], v[216:219], v[176:179], v[32:35]
    ds_read_b64_tr_b16 v[216:217], v249 offset:1536
    ds_read_b64_tr_b16 v[218:219], v249 offset:5632
    v_add_f32 v244, v244, v146
    v_mfma_f32_16x16x32_bf16 v[36:39], v[220:223], v[168:171], v[36:39]
    v_cvt_pk_bf16_f32 v144, v144, v145
    v_mfma_f32_16x16x32_bf16 v[40:43], v[220:223], v[172:175], v[40:43]
    v_add_f32 v244, v244, v147
    v_cvt_pk_bf16_f32 v145, v146, v147
    v_mfma_f32_16x16x32_bf16 v[44:47], v[220:223], v[176:179], v[44:47]
    ds_read_b64_tr_b16 v[220:221], v250 offset:1536
    ds_read_b64_tr_b16 v[222:223], v250 offset:5632
    s_cmp_ge_u32 s46, 131072
    s_cselect_b32 s47, s50, s51
    s_add_u32 s46, s46, s47
    v_add_u32 v249, s47, v249
    v_add_u32 v250, s47, v250
    v_exp_f32 v148, v148
    s_waitcnt lgkmcnt(4)
    v_mfma_f32_16x16x32_bf16 v[48:51], v[208:211], v[168:171], v[48:51]
    v_exp_f32 v149, v149
    v_mfma_f32_16x16x32_bf16 v[52:55], v[208:211], v[172:175], v[52:55]
    buffer_load_dwordx4 v255, s[24:27], s60 offen offset:2048 nt lds
    s_add_u32 s58, s58, s62
    s_add_u32 s60, s60, 16384
    v_exp_f32 v150, v150
    v_mfma_f32_16x16x32_bf16 v[56:59], v[208:211], v[176:179], v[56:59]
    ds_read_b128 v[192:195], v248 offset:0
    v_add_f32 v245, v148, v149
    v_mfma_f32_16x16x32_bf16 v[60:63], v[212:215], v[168:171], v[60:63]
    v_exp_f32 v151, v151
    v_add_f32 v245, v245, v150
    v_mfma_f32_16x16x32_bf16 v[64:67], v[212:215], v[172:175], v[64:67]
    v_cvt_pk_bf16_f32 v148, v148, v149
    v_mfma_f32_16x16x32_bf16 v[68:71], v[212:215], v[176:179], v[68:71]
    ds_read_b128 v[196:199], v248 offset:512
    v_add_f32 v245, v245, v151
    s_waitcnt lgkmcnt(2)
    v_mfma_f32_16x16x32_bf16 v[72:75], v[216:219], v[168:171], v[72:75]
    v_cvt_pk_bf16_f32 v149, v150, v151
    v_mfma_f32_16x16x32_bf16 v[76:79], v[216:219], v[172:175], v[76:79]
    v_exp_f32 v152, v152
    v_exp_f32 v153, v153
    v_mfma_f32_16x16x32_bf16 v[80:83], v[216:219], v[176:179], v[80:83]
    ds_read_b128 v[200:203], v248 offset:1024
    v_exp_f32 v154, v154
    v_mfma_f32_16x16x32_bf16 v[84:87], v[220:223], v[168:171], v[84:87]
    v_add_f32 v246, v152, v153
    v_mfma_f32_16x16x32_bf16 v[88:91], v[220:223], v[172:175], v[88:91]
    v_exp_f32 v155, v155
    v_mfma_f32_16x16x32_bf16 v[92:95], v[220:223], v[176:179], v[92:95]
    ds_read_b128 v[204:207], v248 offset:1536
    v_add_f32 v246, v246, v154
    s_waitcnt lgkmcnt(2)
    v_mfma_f32_16x16x32_bf16 v[168:171], v[192:195], v[96:99], v[224:227]
    v_cvt_pk_bf16_f32 v152, v152, v153
    v_add_f32 v246, v246, v155
    v_mfma_f32_16x16x32_bf16 v[172:175], v[192:195], v[100:103], v[228:231]
    s_mov_b32 m0, s57
    s_cmp_ge_u32 s57, s61
    s_cselect_b32 s62, s50, s51
    buffer_load_dwordx4 v255, s[20:23], s59 offen nt lds
    v_cvt_pk_bf16_f32 v153, v154, v155
    v_exp_f32 v156, v156
    v_mfma_f32_16x16x32_bf16 v[176:179], v[192:195], v[104:107], v[232:235]
    ds_read_b128 v[192:195], v248 offset:4096
    v_exp_f32 v157, v157
    v_mfma_f32_16x16x32_bf16 v[168:171], v[196:199], v[108:111], v[168:171]
    v_add_f32 v244, v244, v156
    v_exp_f32 v158, v158
    v_mfma_f32_16x16x32_bf16 v[172:175], v[196:199], v[112:115], v[172:175]
    v_add_f32 v244, v244, v157
    v_mfma_f32_16x16x32_bf16 v[176:179], v[196:199], v[116:119], v[176:179]
    ds_read_b128 v[196:199], v248 offset:4608
    v_exp_f32 v159, v159
    v_add_f32 v244, v244, v158
    s_waitcnt lgkmcnt(2)
    v_mfma_f32_16x16x32_bf16 v[168:171], v[200:203], v[120:123], v[168:171]
    v_cvt_pk_bf16_f32 v146, v156, v157
    v_mfma_f32_16x16x32_bf16 v[172:175], v[200:203], v[124:127], v[172:175]
    v_add_f32 v244, v244, v159
    v_cvt_pk_bf16_f32 v147, v158, v159
    v_mfma_f32_16x16x32_bf16 v[176:179], v[200:203], v[128:131], v[176:179]
    ds_read_b128 v[200:203], v248 offset:5120
    v_exp_f32 v160, v160
    v_mfma_f32_16x16x32_bf16 v[168:171], v[204:207], v[132:135], v[168:171]
    v_exp_f32 v161, v161
    v_add_f32 v245, v245, v160
    v_mfma_f32_16x16x32_bf16 v[172:175], v[204:207], v[136:139], v[172:175]
    v_exp_f32 v162, v162
    v_mfma_f32_16x16x32_bf16 v[176:179], v[204:207], v[140:143], v[176:179]
    ds_read_b128 v[204:207], v248 offset:5632
    s_cmp_ge_u32 s45, 131072
    s_cselect_b32 s47, s50, s51
    s_add_u32 s45, s45, s47
    v_add_u32 v248, s47, v248
    v_add_f32 v245, v245, v161
    v_exp_f32 v163, v163
    s_waitcnt lgkmcnt(2)
    v_mfma_f32_16x16x32_bf16 v[180:183], v[192:195], v[96:99], v[224:227]
    v_add_f32 v245, v245, v162
    v_mfma_f32_16x16x32_bf16 v[184:187], v[192:195], v[100:103], v[228:231]
    buffer_load_dwordx4 v255, s[20:23], s59 offen offset:2048 nt lds
    s_add_u32 s57, s57, s62
    s_add_u32 s59, s59, 16384
    v_cvt_pk_bf16_f32 v150, v160, v161
    v_add_f32 v245, v245, v163
    v_mfma_f32_16x16x32_bf16 v[188:191], v[192:195], v[104:107], v[232:235]
    ds_read_b64_tr_b16 v[208:209], v249 offset:0
    ds_read_b64_tr_b16 v[210:211], v249 offset:4096
    v_cvt_pk_bf16_f32 v151, v162, v163
    v_mfma_f32_16x16x32_bf16 v[180:183], v[196:199], v[108:111], v[180:183]
    v_exp_f32 v164, v164
    v_exp_f32 v165, v165
    v_mfma_f32_16x16x32_bf16 v[184:187], v[196:199], v[112:115], v[184:187]
    v_add_f32 v246, v246, v164
    v_mfma_f32_16x16x32_bf16 v[188:191], v[196:199], v[116:119], v[188:191]
    ds_read_b64_tr_b16 v[212:213], v250 offset:0
    ds_read_b64_tr_b16 v[214:215], v250 offset:4096
    v_exp_f32 v166, v166
    v_add_f32 v246, v246, v165
    s_waitcnt lgkmcnt(4)
    v_mfma_f32_16x16x32_bf16 v[180:183], v[200:203], v[120:123], v[180:183]
    v_exp_f32 v167, v167
    v_mfma_f32_16x16x32_bf16 v[184:187], v[200:203], v[124:127], v[184:187]
    v_add_f32 v246, v246, v166
    v_cvt_pk_bf16_f32 v154, v164, v165
    v_mfma_f32_16x16x32_bf16 v[188:191], v[200:203], v[128:131], v[188:191]
    ds_read_b64_tr_b16 v[216:217], v249 offset:512
    ds_read_b64_tr_b16 v[218:219], v249 offset:4608
    v_add_f32 v246, v246, v167
    v_mfma_f32_16x16x32_bf16 v[180:183], v[204:207], v[132:135], v[180:183]
    v_cvt_pk_bf16_f32 v155, v166, v167
    v_max3_f32 v236, v244, v245, v246
    v_mfma_f32_16x16x32_bf16 v[184:187], v[204:207], v[136:139], v[184:187]
    v_cmp_nle_f32 vcc, v236, v247
    v_mfma_f32_16x16x32_bf16 v[188:191], v[204:207], v[140:143], v[188:191]
    ds_read_b64_tr_b16 v[220:221], v250 offset:512
    ds_read_b64_tr_b16 v[222:223], v250 offset:4608
    s_cbranch_vccnz P4_RARE
P4_JOIN:
    s_add_u32 s44, s44, 1
    s_cmp_lt_u32 s44, 7
    s_cbranch_scc1 K1_LOOP
    s_waitcnt vmcnt(2)
    s_barrier
    s_waitcnt lgkmcnt(4)
    v_mfma_f32_16x16x32_bf16 v[0:3], v[208:211], v[144:147], v[0:3]
    v_mfma_f32_16x16x32_bf16 v[4:7], v[208:211], v[148:151], v[4:7]
    v_lshrrev_b32 v192, 6, v254
    v_mul_u32_u24 v192, 1152, v192
    v_and_b32 v193, 48, v254
    v_lshlrev_b32 v193, 3, v193
    v_min_u32 v193, 316, v193
    v_add_u32 v192, v192, v193
    buffer_load_dword v167, v192, s[28:31], 0 offen
    v_mfma_f32_16x16x32_bf16 v[8:11], v[208:211], v[152:155], v[8:11]
    ds_read_b64_tr_b16 v[208:209], v249 offset:1024
    ds_read_b64_tr_b16 v[210:211], v249 offset:5120
    v_add_f32 v251, v251, v244
    v_add_f32 v252, v252, v245
    v_add_f32 v253, v253, v246
    v_mfma_f32_16x16x32_bf16 v[12:15], v[212:215], v[144:147], v[12:15]
    v_exp_f32 v168, v168
    v_exp_f32 v169, v169
    v_exp_f32 v170, v170
    v_mfma_f32_16x16x32_bf16 v[16:19], v[212:215], v[148:151], v[16:19]
    v_add_f32 v244, v168, v169
    v_exp_f32 v171, v171
    v_add_f32 v244, v244, v170
    v_mfma_f32_16x16x32_bf16 v[20:23], v[212:215], v[152:155], v[20:23]
    ds_read_b64_tr_b16 v[212:213], v250 offset:1024
    ds_read_b64_tr_b16 v[214:215], v250 offset:5120
    v_cvt_pk_bf16_f32 v168, v168, v169
    v_add_f32 v244, v244, v171
    s_waitcnt lgkmcnt(4)
    v_mfma_f32_16x16x32_bf16 v[24:27], v[216:219], v[144:147], v[24:27]
    v_cvt_pk_bf16_f32 v169, v170, v171
    v_exp_f32 v172, v172
    v_exp_f32 v173, v173
    v_mfma_f32_16x16x32_bf16 v[28:31], v[216:219], v[148:151], v[28:31]
    v_exp_f32 v174, v174
    v_add_f32 v245, v172, v173
    v_exp_f32 v175, v175
    v_mfma_f32_16x16x32_bf16 v[32:35], v[216:219], v[152:155], v[32:35]
    ds_read_b64_tr_b16 v[216:217], v249 offset:1536
    ds_read_b64_tr_b16 v[218:219], v249 offset:5632
    v_add_f32 v245, v245, v174
    v_cvt_pk_bf16_f32 v172, v172, v173
    v_add_f32 v245, v245, v175
    v_mfma_f32_16x16x32_bf16 v[36:39], v[220:223], v[144:147], v[36:39]
    v_cvt_pk_bf16_f32 v173, v174, v175
    v_exp_f32 v176, v176
    v_mfma_f32_16x16x32_bf16 v[40:43], v[220:223], v[148:151], v[40:43]
    v_exp_f32 v177, v177
    v_exp_f32 v178, v178
    v_add_f32 v246, v176, v177
    v_mfma_f32_16x16x32_bf16 v[44:47], v[220:223], v[152:155], v[44:47]
    ds_read_b64_tr_b16 v[220:221], v250 offset:1536
    ds_read_b64_tr_b16 v[222:223], v250 offset:5632
    s_cmp_ge_u32 s46, 131072
    s_cselect_b32 s47, s50, s51
    s_add_u32 s46, s46, s47
    v_add_u32 v249, s47, v249
    v_add_u32 v250, s47, v250
    v_exp_f32 v179, v179
    v_add_f32 v246, v246, v178
    v_cvt_pk_bf16_f32 v176, v176, v177
    s_waitcnt lgkmcnt(4)
    v_mfma_f32_16x16x32_bf16 v[48:51], v[208:211], v[144:147], v[48:51]
    v_add_f32 v246, v246, v179
    v_cvt_pk_bf16_f32 v177, v178, v179
    v_mfma_f32_16x16x32_bf16 v[52:55], v[208:211], v[148:151], v[52:55]
    v_exp_f32 v180, v180
    v_exp_f32 v181, v181
    v_add_f32 v244, v244, v180
    v_mfma_f32_16x16x32_bf16 v[56:59], v[208:211], v[152:155], v[56:59]
    v_exp_f32 v182, v182
    v_add_f32 v244, v244, v181
    v_exp_f32 v183, v183
    v_mfma_f32_16x16x32_bf16 v[60:63], v[212:215], v[144:147], v[60:63]
    v_add_f32 v244, v244, v182
    v_cvt_pk_bf16_f32 v170, v180, v181
    v_add_f32 v244, v244, v183
    v_mfma_f32_16x16x32_bf16 v[64:67], v[212:215], v[148:151], v[64:67]
    v_cvt_pk_bf16_f32 v171, v182, v183
    v_exp_f32 v184, v184
    v_mfma_f32_16x16x32_bf16 v[68:71], v[212:215], v[152:155], v[68:71]
    v_exp_f32 v185, v185
    v_add_f32 v245, v245, v184
    v_exp_f32 v186, v186
    s_waitcnt lgkmcnt(0)
    v_mfma_f32_16x16x32_bf16 v[72:75], v[216:219], v[144:147], v[72:75]
    v_add_f32 v245, v245, v185
    v_exp_f32 v187, v187
    v_add_f32 v245, v245, v186
    v_mfma_f32_16x16x32_bf16 v[76:79], v[216:219], v[148:151], v[76:79]
    v_cvt_pk_bf16_f32 v174, v184, v185
    v_add_f32 v245, v245, v187
    v_cvt_pk_bf16_f32 v175, v186, v187
    v_mfma_f32_16x16x32_bf16 v[80:83], v[216:219], v[152:155], v[80:83]
    v_exp_f32 v188, v188
    v_exp_f32 v189, v189
    v_mfma_f32_16x16x32_bf16 v[84:87], v[220:223], v[144:147], v[84:87]
    v_add_f32 v246, v246, v188
    v_exp_f32 v190, v190
    v_add_f32 v246, v246, v189
    v_mfma_f32_16x16x32_bf16 v[88:91], v[220:223], v[148:151], v[88:91]
    v_exp_f32 v191, v191
    v_add_f32 v246, v246, v190
    v_cvt_pk_bf16_f32 v178, v188, v189
    v_mfma_f32_16x16x32_bf16 v[92:95], v[220:223], v[152:155], v[92:95]
    v_add_f32 v246, v246, v191
    v_cvt_pk_bf16_f32 v179, v190, v191
    s_waitcnt vmcnt(1)
    s_barrier
    s_bitcmp1_b32 15, s42
    s_cbranch_scc0 RL3
    ds_read_b64_tr_b16 v[208:209], v249 offset:1024
    ds_read_b64_tr_b16 v[210:211], v249 offset:5120
    ds_read_b64_tr_b16 v[212:213], v250 offset:1024
    ds_read_b64_tr_b16 v[214:215], v250 offset:5120
    ds_read_b64_tr_b16 v[216:217], v249 offset:1536
    ds_read_b64_tr_b16 v[218:219], v249 offset:5632
    ds_read_b64_tr_b16 v[220:221], v250 offset:1536
    ds_read_b64_tr_b16 v[222:223], v250 offset:5632
RL3:
    s_bitcmp1_b32 240, s42
    s_cbranch_scc0 RL4
    ds_read_b64_tr_b16 v[208:209], v249 offset:0
    ds_read_b64_tr_b16 v[210:211], v249 offset:4096
    ds_read_b64_tr_b16 v[212:213], v250 offset:0
    ds_read_b64_tr_b16 v[214:215], v250 offset:4096
    ds_read_b64_tr_b16 v[216:217], v249 offset:512
    ds_read_b64_tr_b16 v[218:219], v249 offset:4608
    ds_read_b64_tr_b16 v[220:221], v250 offset:512
    ds_read_b64_tr_b16 v[222:223], v250 offset:4608
RL4:
    s_mul_i32 s43, s42, 12288
    s_xor_b32 s46, s42, 4
    s_mul_i32 s46, s46, 12288
    s_add_u32 s43, s43, 65536
    s_add_u32 s46, s46, 65536
    v_add_u32 v164, s43, v254
    v_add_u32 v165, s46, v254
    v_max3_f32 v236, v244, v245, v246
    v_cmp_nle_f32 vcc, v236, v247
    s_cbranch_vccnz L2_RARE
L2_JOIN:
    s_bitcmp1_b32 15, s42
    s_cbranch_scc0 RL5
    s_waitcnt lgkmcnt(4)
    v_mfma_f32_16x16x32_bf16 v[48:51], v[208:211], v[168:171], v[48:51]
    v_mfma_f32_16x16x32_bf16 v[52:55], v[208:211], v[172:175], v[52:55]
    v_add_f32 v251, v251, v244
    v_add_f32 v252, v252, v245
    v_add_f32 v253, v253, v246
    v_mfma_f32_16x16x32_bf16 v[56:59], v[208:211], v[176:179], v[56:59]
    ds_read_b64_tr_b16 v[208:209], v249 offset:0
    ds_read_b64_tr_b16 v[210:211], v249 offset:4096
    v_mov_b32 v240, v251
    v_mov_b32 v241, v252
    v_mov_b32 v242, v253
    v_mfma_f32_16x16x32_bf16 v[60:63], v[212:215], v[168:171], v[60:63]
    v_permlane32_swap_b32 v251, v240
    v_permlane32_swap_b32 v252, v241
    v_permlane32_swap_b32 v253, v242
    v_mfma_f32_16x16x32_bf16 v[64:67], v[212:215], v[172:175], v[64:67]
    v_add_f32 v251, v251, v240
    v_add_f32 v252, v252, v241
    v_add_f32 v253, v253, v242
    v_mfma_f32_16x16x32_bf16 v[68:71], v[212:215], v[176:179], v[68:71]
    ds_read_b64_tr_b16 v[212:213], v250 offset:0
    ds_read_b64_tr_b16 v[214:215], v250 offset:4096
    v_mov_b32 v240, v251
    v_mov_b32 v241, v252
    v_mov_b32 v242, v253
    s_waitcnt lgkmcnt(4)
    v_mfma_f32_16x16x32_bf16 v[72:75], v[216:219], v[168:171], v[72:75]
    v_permlane16_swap_b32 v251, v240
    v_permlane16_swap_b32 v252, v241
    v_mfma_f32_16x16x32_bf16 v[76:79], v[216:219], v[172:175], v[76:79]
    v_permlane16_swap_b32 v253, v242
    v_add_f32 v251, v251, v240
    v_add_f32 v252, v252, v241
    v_mfma_f32_16x16x32_bf16 v[80:83], v[216:219], v[176:179], v[80:83]
    ds_read_b64_tr_b16 v[216:217], v249 offset:512
    ds_read_b64_tr_b16 v[218:219], v249 offset:4608
    v_add_f32 v253, v253, v242
    s_lshr_b32 s47, s41, 3
    s_and_b32 s48, s41, 7
    s_lshr_b32 s49, s48, 2
    s_and_b32 s50, s48, 3
    v_mfma_f32_16x16x32_bf16 v[84:87], v[220:223], v[168:171], v[84:87]
    s_and_b32 s51, s50, 1
    s_mul_i32 s55, s47, 1179648
    s_mul_i32 s61, s50, 288
    s_add_u32 s55, s55, s61
    s_lshl_b32 s61, s51, 5
    s_sub_u32 s55, s55, s61
    v_mfma_f32_16x16x32_bf16 v[88:91], v[220:223], v[172:175], v[88:91]
    s_mul_i32 s61, s40, 1572864
    s_mul_i32 s100, s49, 786432
    s_add_u32 s61, s61, s100
    s_lshl_b32 s100, s47, 15
    s_add_u32 s61, s61, s100
    s_sub_u32 s22, 4718592, s55
    v_mfma_f32_16x16x32_bf16 v[92:95], v[220:223], v[176:179], v[92:95]
    ds_read_b64_tr_b16 v[220:221], v250 offset:512
    ds_read_b64_tr_b16 v[222:223], v250 offset:4608
    s_add_u32 s20, s12, s55
    s_addc_u32 s21, s13, 0
    s_add_u32 s24, s18, s61
    s_addc_u32 s25, s19, 0
    s_waitcnt lgkmcnt(4)
    v_mfma_f32_16x16x32_bf16 v[0:3], v[208:211], v[168:171], v[0:3]
    s_mov_b32 s23, 0x20000
    s_mov_b32 s26, 688128
    s_mov_b32 s27, 0x20000
    ds_write_b128 v164, v[48:51] offset:0
    s_lshl_b32 s52, s40, 3
    s_add_u32 s52, s52, s48
    v_mfma_f32_16x16x32_bf16 v[4:7], v[208:211], v[172:175], v[4:7]
    ds_write_b128 v164, v[52:55] offset:1024
    s_mul_i32 s52, s52, 147456
    s_add_u32 s52, s52, 33554432
    v_mfma_f32_16x16x32_bf16 v[8:11], v[208:211], v[176:179], v[8:11]
    ds_write_b128 v164, v[56:59] offset:2048
    s_mul_i32 s61, s47, 9216
    s_add_u32 s61, s61, s52
    v_mfma_f32_16x16x32_bf16 v[12:15], v[212:215], v[168:171], v[12:15]
    ds_write_b128 v164, v[60:63] offset:3072
    s_add_u32 s28, s18, s61
    s_addc_u32 s29, s19, 0
    v_mfma_f32_16x16x32_bf16 v[16:19], v[212:215], v[172:175], v[16:19]
    ds_write_b128 v164, v[64:67] offset:4096
    s_mov_b32 s30, 119808
    s_mov_b32 s31, 0x20000
    v_mfma_f32_16x16x32_bf16 v[20:23], v[212:215], v[176:179], v[20:23]
    ds_write_b128 v164, v[68:71] offset:5120
    s_mul_i32 s61, s47, 36864
    s_add_u32 s61, s61, s52
    s_waitcnt lgkmcnt(6)
    v_mfma_f32_16x16x32_bf16 v[24:27], v[216:219], v[168:171], v[24:27]
    ds_write_b128 v164, v[72:75] offset:6144
    s_add_u32 s32, s18, s61
    s_addc_u32 s33, s19, 0
    ds_write_b128 v164, v[76:79] offset:7168
    v_mfma_f32_16x16x32_bf16 v[28:31], v[216:219], v[172:175], v[28:31]
    s_mov_b32 s34, 36864
    s_mov_b32 s35, 0x20000
    ds_write_b128 v164, v[80:83] offset:8192
    v_mfma_f32_16x16x32_bf16 v[32:35], v[216:219], v[176:179], v[32:35]
    s_mul_i32 s52, s40, 192
    s_mul_i32 s61, s49, 96
    ds_write_b128 v164, v[84:87] offset:9216
    v_mfma_f32_16x16x32_bf16 v[36:39], v[220:223], v[168:171], v[36:39]
    s_add_u32 s52, s52, s61
    s_lshl_b32 s61, s47, 2
    ds_write_b128 v164, v[88:91] offset:10240
    v_mfma_f32_16x16x32_bf16 v[40:43], v[220:223], v[172:175], v[40:43]
    s_add_u32 s52, s52, s61
    s_mul_i32 s52, s52, 1152
    ds_write_b128 v164, v[92:95] offset:11264
    v_mfma_f32_16x16x32_bf16 v[44:47], v[220:223], v[176:179], v[44:47]
    s_mul_i32 s61, s50, 288
    s_add_u32 s6, s52, s61
    s_lshr_b32 s100, s50, 1
    s_and_b32 s99, s90, 0xfffffc00
RL5:
    s_bitcmp1_b32 240, s42
    s_cbranch_scc0 RL6
    s_waitcnt lgkmcnt(4)
    v_mfma_f32_16x16x32_bf16 v[0:3], v[208:211], v[168:171], v[0:3]
    v_mfma_f32_16x16x32_bf16 v[4:7], v[208:211], v[172:175], v[4:7]
    v_add_f32 v251, v251, v244
    v_add_f32 v252, v252, v245
    v_add_f32 v253, v253, v246
    v_mfma_f32_16x16x32_bf16 v[8:11], v[208:211], v[176:179], v[8:11]
    ds_read_b64_tr_b16 v[208:209], v249 offset:1024
    ds_read_b64_tr_b16 v[210:211], v249 offset:5120
    v_mov_b32 v240, v251
    v_mov_b32 v241, v252
    v_mov_b32 v242, v253
    v_mfma_f32_16x16x32_bf16 v[12:15], v[212:215], v[168:171], v[12:15]
    v_permlane32_swap_b32 v251, v240
    v_permlane32_swap_b32 v252, v241
    v_permlane32_swap_b32 v253, v242
    v_mfma_f32_16x16x32_bf16 v[16:19], v[212:215], v[172:175], v[16:19]
    v_add_f32 v251, v251, v240
    v_add_f32 v252, v252, v241
    v_add_f32 v253, v253, v242
    v_mfma_f32_16x16x32_bf16 v[20:23], v[212:215], v[176:179], v[20:23]
    ds_read_b64_tr_b16 v[212:213], v250 offset:1024
    ds_read_b64_tr_b16 v[214:215], v250 offset:5120
    v_mov_b32 v240, v251
    v_mov_b32 v241, v252
    v_mov_b32 v242, v253
    s_waitcnt lgkmcnt(4)
    v_mfma_f32_16x16x32_bf16 v[24:27], v[216:219], v[168:171], v[24:27]
    v_permlane16_swap_b32 v251, v240
    v_permlane16_swap_b32 v252, v241
    v_mfma_f32_16x16x32_bf16 v[28:31], v[216:219], v[172:175], v[28:31]
    v_permlane16_swap_b32 v253, v242
    v_add_f32 v251, v251, v240
    v_add_f32 v252, v252, v241
    v_mfma_f32_16x16x32_bf16 v[32:35], v[216:219], v[176:179], v[32:35]
    ds_read_b64_tr_b16 v[216:217], v249 offset:1536
    ds_read_b64_tr_b16 v[218:219], v249 offset:5632
    v_add_f32 v253, v253, v242
    s_lshr_b32 s47, s41, 3
    s_and_b32 s48, s41, 7
    s_lshr_b32 s49, s48, 2
    s_and_b32 s50, s48, 3
    v_mfma_f32_16x16x32_bf16 v[36:39], v[220:223], v[168:171], v[36:39]
    s_and_b32 s51, s50, 1
    s_mul_i32 s55, s47, 1179648
    s_mul_i32 s61, s50, 288
    s_add_u32 s55, s55, s61
    s_lshl_b32 s61, s51, 5
    s_sub_u32 s55, s55, s61
    v_mfma_f32_16x16x32_bf16 v[40:43], v[220:223], v[172:175], v[40:43]
    s_mul_i32 s61, s40, 1572864
    s_mul_i32 s100, s49, 786432
    s_add_u32 s61, s61, s100
    s_lshl_b32 s100, s47, 15
    s_add_u32 s61, s61, s100
    s_sub_u32 s22, 4718592, s55
    v_mfma_f32_16x16x32_bf16 v[44:47], v[220:223], v[176:179], v[44:47]
    ds_read_b64_tr_b16 v[220:221], v250 offset:1536
    ds_read_b64_tr_b16 v[222:223], v250 offset:5632
    s_add_u32 s20, s12, s55
    s_addc_u32 s21, s13, 0
    s_add_u32 s24, s18, s61
    s_addc_u32 s25, s19, 0
    s_waitcnt lgkmcnt(4)
    v_mfma_f32_16x16x32_bf16 v[48:51], v[208:211], v[168:171], v[48:51]
    s_mov_b32 s23, 0x20000
    s_mov_b32 s26, 688128
    s_mov_b32 s27, 0x20000
    ds_write_b128 v164, v[0:3] offset:0
    s_lshl_b32 s52, s40, 3
    s_add_u32 s52, s52, s48
    v_mfma_f32_16x16x32_bf16 v[52:55], v[208:211], v[172:175], v[52:55]
    ds_write_b128 v164, v[4:7] offset:1024
    s_mul_i32 s52, s52, 147456
    s_add_u32 s52, s52, 33554432
    v_mfma_f32_16x16x32_bf16 v[56:59], v[208:211], v[176:179], v[56:59]
    ds_write_b128 v164, v[8:11] offset:2048
    s_mul_i32 s61, s47, 9216
    s_add_u32 s61, s61, s52
    v_mfma_f32_16x16x32_bf16 v[60:63], v[212:215], v[168:171], v[60:63]
    ds_write_b128 v164, v[12:15] offset:3072
    s_add_u32 s28, s18, s61
    s_addc_u32 s29, s19, 0
    v_mfma_f32_16x16x32_bf16 v[64:67], v[212:215], v[172:175], v[64:67]
    ds_write_b128 v164, v[16:19] offset:4096
    s_mov_b32 s30, 119808
    s_mov_b32 s31, 0x20000
    v_mfma_f32_16x16x32_bf16 v[68:71], v[212:215], v[176:179], v[68:71]
    ds_write_b128 v164, v[20:23] offset:5120
    s_mul_i32 s61, s47, 36864
    s_add_u32 s61, s61, s52
    s_waitcnt lgkmcnt(6)
    v_mfma_f32_16x16x32_bf16 v[72:75], v[216:219], v[168:171], v[72:75]
    ds_write_b128 v164, v[24:27] offset:6144
    s_add_u32 s32, s18, s61
    s_addc_u32 s33, s19, 0
    ds_write_b128 v164, v[28:31] offset:7168
    v_mfma_f32_16x16x32_bf16 v[76:79], v[216:219], v[172:175], v[76:79]
    s_mov_b32 s34, 36864
    s_mov_b32 s35, 0x20000
    ds_write_b128 v164, v[32:35] offset:8192
    v_mfma_f32_16x16x32_bf16 v[80:83], v[216:219], v[176:179], v[80:83]
    s_mul_i32 s52, s40, 192
    s_mul_i32 s61, s49, 96
    ds_write_b128 v164, v[36:39] offset:9216
    v_mfma_f32_16x16x32_bf16 v[84:87], v[220:223], v[168:171], v[84:87]
    s_add_u32 s52, s52, s61
    s_lshl_b32 s61, s47, 2
    ds_write_b128 v164, v[40:43] offset:10240
    v_mfma_f32_16x16x32_bf16 v[88:91], v[220:223], v[172:175], v[88:91]
    s_add_u32 s52, s52, s61
    s_mul_i32 s52, s52, 1152
    ds_write_b128 v164, v[44:47] offset:11264
    v_mfma_f32_16x16x32_bf16 v[92:95], v[220:223], v[176:179], v[92:95]
    s_mul_i32 s61, s50, 288
    s_add_u32 s6, s52, s61
    s_lshr_b32 s100, s50, 1
    s_and_b32 s99, s90, 0xfffffc00
RL6:
    s_xor_b32 s46, s42, 4
    v_lshrrev_b32 v250, 1, v254
    s_mul_i32 s43, s42, 1536
    s_mul_i32 s45, s46, 1536
    s_add_u32 s43, s43, 24576
    s_add_u32 s45, s45, 24576
    v_add_u32 v255, s43, v250
    v_add_u32 v250, s45, v250
    v_mov_b32 v225, v251
    v_mov_b32 v229, v252
    v_mov_b32 v233, v253
    ds_write_b64 v255, v[224:225] offset:0
    ds_write_b64 v255, v[228:229] offset:512
    ds_write_b64 v255, v[232:233] offset:1024
    s_and_b32 s43, s42, 3
    s_mul_i32 s43, s43, 393216
    s_lshl_b32 s45, s41, 12
    s_add_u32 s43, s43, s45
    s_lshl_b32 s45, s54, 11
    s_add_u32 s43, s43, s45
    s_add_u32 s45, s43, 131072
    s_add_u32 s46, s43, 262144
    s_waitcnt lgkmcnt(0)
    s_barrier
    ds_read_b64 v[144:145], v250 offset:0
    ds_read_b64 v[146:147], v250 offset:512
    ds_read_b64 v[148:149], v250 offset:1024
    ds_read_b128 v[96:99], v165 offset:0
    ds_read_b128 v[100:103], v165 offset:1024
    ds_read_b128 v[104:107], v165 offset:2048
    ds_read_b128 v[108:111], v165 offset:3072
    ds_read_b128 v[112:115], v165 offset:4096
    ds_read_b128 v[116:119], v165 offset:5120
    ds_read_b128 v[120:123], v165 offset:6144
    ds_read_b128 v[124:127], v165 offset:7168
    ds_read_b128 v[128:131], v165 offset:8192
    ds_read_b128 v[132:135], v165 offset:9216
    ds_read_b128 v[136:139], v165 offset:10240
    ds_read_b128 v[140:143], v165 offset:11264
    s_waitcnt lgkmcnt(12)
    v_min_f32 v236, v224, v144
    v_min_f32 v240, v228, v146
    v_min_f32 v244, v232, v148
    v_sub_f32 v237, v236, v224
    v_sub_f32 v241, v240, v228
    v_sub_f32 v245, v244, v232
    v_sub_f32 v238, v236, v144
    v_sub_f32 v242, v240, v146
    v_sub_f32 v246, v244, v148
    v_exp_f32 v237, v237
    v_exp_f32 v241, v241
    v_exp_f32 v245, v245
    v_exp_f32 v238, v238
    v_exp_f32 v242, v242
    v_exp_f32 v246, v246
    v_mul_f32 v239, v237, v225
    v_mul_f32 v243, v241, v229
    v_mul_f32 v247, v245, v233
    v_fmac_f32 v239, v238, v145
    v_fmac_f32 v243, v242, v147
    v_fmac_f32 v247, v246, v149
    v_rcp_f32 v239, v239
    v_rcp_f32 v243, v243
    v_rcp_f32 v247, v247
    s_nop 0
    v_mul_f32 v152, v237, v239
    v_mul_f32 v156, v241, v243
    v_mul_f32 v160, v245, v247
    v_mul_f32 v153, v237, v239
    v_mul_f32 v157, v241, v243
    v_mul_f32 v161, v245, v247
    v_mul_f32 v154, v238, v239
    v_mul_f32 v158, v242, v243
    v_mul_f32 v162, v246, v247
    v_mul_f32 v155, v238, v239
    v_mul_f32 v159, v242, v243
    v_mul_f32 v163, v246, v247
    s_bitcmp1_b32 15, s42
    s_cbranch_scc0 RL7
    s_waitcnt lgkmcnt(11)
    v_pk_mul_f32 v[0:1], v[0:1], v[152:153]
    v_pk_mul_f32 v[2:3], v[2:3], v[152:153]
    v_pk_fma_f32 v[0:1], v[96:97], v[154:155], v[0:1]
    v_pk_fma_f32 v[2:3], v[98:99], v[154:155], v[2:3]
    v_cvt_pk_bf16_f32 v168, v0, v1
    v_cvt_pk_bf16_f32 v169, v2, v3
    s_waitcnt lgkmcnt(8)
    v_pk_mul_f32 v[12:13], v[12:13], v[152:153]
    v_pk_mul_f32 v[14:15], v[14:15], v[152:153]
    v_pk_fma_f32 v[12:13], v[108:109], v[154:155], v[12:13]
    v_pk_fma_f32 v[14:15], v[110:111], v[154:155], v[14:15]
    v_cvt_pk_bf16_f32 v170, v12, v13
    v_cvt_pk_bf16_f32 v171, v14, v15
    buffer_store_dwordx4 v[168:171], v254, s[36:39], s43 offen offset:0 sc1
    v_pk_mul_f32 v[4:5], v[4:5], v[156:157]
    v_pk_mul_f32 v[6:7], v[6:7], v[156:157]
    v_pk_fma_f32 v[4:5], v[100:101], v[158:159], v[4:5]
    v_pk_fma_f32 v[6:7], v[102:103], v[158:159], v[6:7]
    v_cvt_pk_bf16_f32 v172, v4, v5
    v_cvt_pk_bf16_f32 v173, v6, v7
    s_waitcnt lgkmcnt(7)
    v_pk_mul_f32 v[16:17], v[16:17], v[156:157]
    v_pk_mul_f32 v[18:19], v[18:19], v[156:157]
    v_pk_fma_f32 v[16:17], v[112:113], v[158:159], v[16:17]
    v_pk_fma_f32 v[18:19], v[114:115], v[158:159], v[18:19]
    v_cvt_pk_bf16_f32 v174, v16, v17
    v_cvt_pk_bf16_f32 v175, v18, v19
    buffer_store_dwordx4 v[172:175], v254, s[36:39], s45 offen offset:0 sc1
    v_pk_mul_f32 v[8:9], v[8:9], v[160:161]
    v_pk_mul_f32 v[10:11], v[10:11], v[160:161]
    v_pk_fma_f32 v[8:9], v[104:105], v[162:163], v[8:9]
    v_pk_fma_f32 v[10:11], v[106:107], v[162:163], v[10:11]
    v_cvt_pk_bf16_f32 v176, v8, v9
    v_cvt_pk_bf16_f32 v177, v10, v11
    s_waitcnt lgkmcnt(6)
    v_pk_mul_f32 v[20:21], v[20:21], v[160:161]
    v_pk_mul_f32 v[22:23], v[22:23], v[160:161]
    v_pk_fma_f32 v[20:21], v[116:117], v[162:163], v[20:21]
    v_pk_fma_f32 v[22:23], v[118:119], v[162:163], v[22:23]
    v_cvt_pk_bf16_f32 v178, v20, v21
    v_cvt_pk_bf16_f32 v179, v22, v23
    buffer_store_dwordx4 v[176:179], v254, s[36:39], s46 offen offset:0 sc1
    s_waitcnt lgkmcnt(5)
    v_pk_mul_f32 v[24:25], v[24:25], v[152:153]
    v_pk_mul_f32 v[26:27], v[26:27], v[152:153]
    v_pk_fma_f32 v[24:25], v[120:121], v[154:155], v[24:25]
    v_pk_fma_f32 v[26:27], v[122:123], v[154:155], v[26:27]
    v_cvt_pk_bf16_f32 v180, v24, v25
    v_cvt_pk_bf16_f32 v181, v26, v27
    s_waitcnt lgkmcnt(2)
    v_pk_mul_f32 v[36:37], v[36:37], v[152:153]
    v_pk_mul_f32 v[38:39], v[38:39], v[152:153]
    v_pk_fma_f32 v[36:37], v[132:133], v[154:155], v[36:37]
    v_pk_fma_f32 v[38:39], v[134:135], v[154:155], v[38:39]
    v_cvt_pk_bf16_f32 v182, v36, v37
    v_cvt_pk_bf16_f32 v183, v38, v39
    buffer_store_dwordx4 v[180:183], v254, s[36:39], s43 offen offset:1024 sc1
    v_pk_mul_f32 v[28:29], v[28:29], v[156:157]
    v_pk_mul_f32 v[30:31], v[30:31], v[156:157]
    v_pk_fma_f32 v[28:29], v[124:125], v[158:159], v[28:29]
    v_pk_fma_f32 v[30:31], v[126:127], v[158:159], v[30:31]
    v_cvt_pk_bf16_f32 v184, v28, v29
    v_cvt_pk_bf16_f32 v185, v30, v31
    s_waitcnt lgkmcnt(1)
    v_pk_mul_f32 v[40:41], v[40:41], v[156:157]
    v_pk_mul_f32 v[42:43], v[42:43], v[156:157]
    v_pk_fma_f32 v[40:41], v[136:137], v[158:159], v[40:41]
    v_pk_fma_f32 v[42:43], v[138:139], v[158:159], v[42:43]
    v_cvt_pk_bf16_f32 v186, v40, v41
    v_cvt_pk_bf16_f32 v187, v42, v43
    buffer_store_dwordx4 v[184:187], v254, s[36:39], s45 offen offset:1024 sc1
    v_pk_mul_f32 v[32:33], v[32:33], v[160:161]
    v_pk_mul_f32 v[34:35], v[34:35], v[160:161]
    v_pk_fma_f32 v[32:33], v[128:129], v[162:163], v[32:33]
    v_pk_fma_f32 v[34:35], v[130:131], v[162:163], v[34:35]
    v_cvt_pk_bf16_f32 v188, v32, v33
    v_cvt_pk_bf16_f32 v189, v34, v35
    s_waitcnt lgkmcnt(0)
    v_pk_mul_f32 v[44:45], v[44:45], v[160:161]
    v_pk_mul_f32 v[46:47], v[46:47], v[160:161]
    v_pk_fma_f32 v[44:45], v[140:141], v[162:163], v[44:45]
    v_pk_fma_f32 v[46:47], v[142:143], v[162:163], v[46:47]
    v_cvt_pk_bf16_f32 v190, v44, v45
    v_cvt_pk_bf16_f32 v191, v46, v47
    buffer_store_dwordx4 v[188:191], v254, s[36:39], s46 offen offset:1024 sc1
RL7:
    s_bitcmp1_b32 240, s42
    s_cbranch_scc0 RL8
    s_waitcnt lgkmcnt(11)
    v_pk_mul_f32 v[48:49], v[48:49], v[152:153]
    v_pk_mul_f32 v[50:51], v[50:51], v[152:153]
    v_pk_fma_f32 v[48:49], v[96:97], v[154:155], v[48:49]
    v_pk_fma_f32 v[50:51], v[98:99], v[154:155], v[50:51]
    v_cvt_pk_bf16_f32 v168, v48, v49
    v_cvt_pk_bf16_f32 v169, v50, v51
    s_waitcnt lgkmcnt(8)
    v_pk_mul_f32 v[60:61], v[60:61], v[152:153]
    v_pk_mul_f32 v[62:63], v[62:63], v[152:153]
    v_pk_fma_f32 v[60:61], v[108:109], v[154:155], v[60:61]
    v_pk_fma_f32 v[62:63], v[110:111], v[154:155], v[62:63]
    v_cvt_pk_bf16_f32 v170, v60, v61
    v_cvt_pk_bf16_f32 v171, v62, v63
    buffer_store_dwordx4 v[168:171], v254, s[36:39], s43 offen offset:0 sc1
    v_pk_mul_f32 v[52:53], v[52:53], v[156:157]
    v_pk_mul_f32 v[54:55], v[54:55], v[156:157]
    v_pk_fma_f32 v[52:53], v[100:101], v[158:159], v[52:53]
    v_pk_fma_f32 v[54:55], v[102:103], v[158:159], v[54:55]
    v_cvt_pk_bf16_f32 v172, v52, v53
    v_cvt_pk_bf16_f32 v173, v54, v55
    s_waitcnt lgkmcnt(7)
    v_pk_mul_f32 v[64:65], v[64:65], v[156:157]
    v_pk_mul_f32 v[66:67], v[66:67], v[156:157]
    v_pk_fma_f32 v[64:65], v[112:113], v[158:159], v[64:65]
    v_pk_fma_f32 v[66:67], v[114:115], v[158:159], v[66:67]
    v_cvt_pk_bf16_f32 v174, v64, v65
    v_cvt_pk_bf16_f32 v175, v66, v67
    buffer_store_dwordx4 v[172:175], v254, s[36:39], s45 offen offset:0 sc1
    v_pk_mul_f32 v[56:57], v[56:57], v[160:161]
    v_pk_mul_f32 v[58:59], v[58:59], v[160:161]
    v_pk_fma_f32 v[56:57], v[104:105], v[162:163], v[56:57]
    v_pk_fma_f32 v[58:59], v[106:107], v[162:163], v[58:59]
    v_cvt_pk_bf16_f32 v176, v56, v57
    v_cvt_pk_bf16_f32 v177, v58, v59
    s_waitcnt lgkmcnt(6)
    v_pk_mul_f32 v[68:69], v[68:69], v[160:161]
    v_pk_mul_f32 v[70:71], v[70:71], v[160:161]
    v_pk_fma_f32 v[68:69], v[116:117], v[162:163], v[68:69]
    v_pk_fma_f32 v[70:71], v[118:119], v[162:163], v[70:71]
    v_cvt_pk_bf16_f32 v178, v68, v69
    v_cvt_pk_bf16_f32 v179, v70, v71
    buffer_store_dwordx4 v[176:179], v254, s[36:39], s46 offen offset:0 sc1
    s_waitcnt lgkmcnt(5)
    v_pk_mul_f32 v[72:73], v[72:73], v[152:153]
    v_pk_mul_f32 v[74:75], v[74:75], v[152:153]
    v_pk_fma_f32 v[72:73], v[120:121], v[154:155], v[72:73]
    v_pk_fma_f32 v[74:75], v[122:123], v[154:155], v[74:75]
    v_cvt_pk_bf16_f32 v180, v72, v73
    v_cvt_pk_bf16_f32 v181, v74, v75
    s_waitcnt lgkmcnt(2)
    v_pk_mul_f32 v[84:85], v[84:85], v[152:153]
    v_pk_mul_f32 v[86:87], v[86:87], v[152:153]
    v_pk_fma_f32 v[84:85], v[132:133], v[154:155], v[84:85]
    v_pk_fma_f32 v[86:87], v[134:135], v[154:155], v[86:87]
    v_cvt_pk_bf16_f32 v182, v84, v85
    v_cvt_pk_bf16_f32 v183, v86, v87
    buffer_store_dwordx4 v[180:183], v254, s[36:39], s43 offen offset:1024 sc1
    v_pk_mul_f32 v[76:77], v[76:77], v[156:157]
    v_pk_mul_f32 v[78:79], v[78:79], v[156:157]
    v_pk_fma_f32 v[76:77], v[124:125], v[158:159], v[76:77]
    v_pk_fma_f32 v[78:79], v[126:127], v[158:159], v[78:79]
    v_cvt_pk_bf16_f32 v184, v76, v77
    v_cvt_pk_bf16_f32 v185, v78, v79
    s_waitcnt lgkmcnt(1)
    v_pk_mul_f32 v[88:89], v[88:89], v[156:157]
    v_pk_mul_f32 v[90:91], v[90:91], v[156:157]
    v_pk_fma_f32 v[88:89], v[136:137], v[158:159], v[88:89]
    v_pk_fma_f32 v[90:91], v[138:139], v[158:159], v[90:91]
    v_cvt_pk_bf16_f32 v186, v88, v89
    v_cvt_pk_bf16_f32 v187, v90, v91
    buffer_store_dwordx4 v[184:187], v254, s[36:39], s45 offen offset:1024 sc1
    v_pk_mul_f32 v[80:81], v[80:81], v[160:161]
    v_pk_mul_f32 v[82:83], v[82:83], v[160:161]
    v_pk_fma_f32 v[80:81], v[128:129], v[162:163], v[80:81]
    v_pk_fma_f32 v[82:83], v[130:131], v[162:163], v[82:83]
    v_cvt_pk_bf16_f32 v188, v80, v81
    v_cvt_pk_bf16_f32 v189, v82, v83
    s_waitcnt lgkmcnt(0)
    v_pk_mul_f32 v[92:93], v[92:93], v[160:161]
    v_pk_mul_f32 v[94:95], v[94:95], v[160:161]
    v_pk_fma_f32 v[92:93], v[140:141], v[162:163], v[92:93]
    v_pk_fma_f32 v[94:95], v[142:143], v[162:163], v[94:95]
    v_cvt_pk_bf16_f32 v190, v92, v93
    v_cvt_pk_bf16_f32 v191, v94, v95
    buffer_store_dwordx4 v[188:191], v254, s[36:39], s46 offen offset:1024 sc1
RL8:
    s_bfe_u32 s43, s42, 0x10001
    s_cmp_eq_u32 s43, s49
    s_cbranch_scc0 OWN_SKIP
    s_and_b32 s43, s42, 1
    s_mul_i32 s43, s43, 6144
    s_mul_i32 s45, s54, 12288
    s_add_u32 s43, s43, s45
    v_add_u32 v248, s43, v254
    ds_write_b128 v248, v[168:171] offset:0
    ds_write_b128 v248, v[172:175] offset:2048
    ds_write_b128 v248, v[176:179] offset:4096
    ds_write_b128 v248, v[180:183] offset:1024
    ds_write_b128 v248, v[184:187] offset:3072
    ds_write_b128 v248, v[188:191] offset:5120
OWN_SKIP:
    v_lshrrev_b32 v201, 4, v254
    v_and_b32 v216, 3, v201
    s_bitcmp1_b32 63, s42
    s_cbranch_scc0 RL9
    s_and_b32 s43, s42, 1
    s_cmp_lt_u32 s42, 2
    s_cselect_b32 s45, 5, 0
    s_cmp_ge_u32 s42, 4
    s_cselect_b32 s45, 7, s45
    v_lshrrev_b32 v217, 4, v201
    v_bfe_u32 v218, v201, 2, 4
    v_and_b32 v220, 7, v218
    v_lshlrev_b32 v220, 6, v220
    v_lshlrev_b32 v218, 6, v218
    v_and_b32 v219, 1, v217
    v_lshlrev_b32 v219, 5, v219
    v_lshl_add_u32 v219, v216, 3, v219
    v_add_u32 v218, v218, v219
    v_add_u32 v220, v220, v219
    v_lshrrev_b32 v219, 1, v217
    v_lshl_add_u32 v220, v219, 12, v220
    s_add_u32 s101, s45, s51
    s_add_u32 s52, s101, 0
    s_and_b32 s91, s52, 1
    s_lshl_b32 s91, s91, 5
    s_lshr_b32 s52, s52, 1
    s_sub_u32 s52, s52, s100
    s_and_b32 s54, s52, 1
    s_lshl_b32 s54, s54, 9
    s_lshr_b32 s55, s52, 1
    s_lshl_b32 s55, s55, 13
    s_add_u32 s54, s54, s55
    s_cmp_lt_u32 s52, 4
    s_cselect_b32 s54, s54, 16384
    s_cselect_b64 vcc, -1, 0
    s_add_u32 s54, s54, 36864
    v_cndmask_b32 v192, v218, v220, vcc
    v_xor_b32 v192, s91, v192
    v_add_u32 v192, s54, v192
    s_add_u32 s52, s101, 1
    s_and_b32 s91, s52, 1
    s_lshl_b32 s91, s91, 5
    s_lshr_b32 s52, s52, 1
    s_sub_u32 s52, s52, s100
    s_and_b32 s54, s52, 1
    s_lshl_b32 s54, s54, 9
    s_lshr_b32 s55, s52, 1
    s_lshl_b32 s55, s55, 13
    s_add_u32 s54, s54, s55
    s_cmp_lt_u32 s52, 4
    s_cselect_b32 s54, s54, 16384
    s_cselect_b64 vcc, -1, 0
    s_add_u32 s54, s54, 36864
    v_cndmask_b32 v193, v218, v220, vcc
    v_xor_b32 v193, s91, v193
    v_add_u32 v193, s54, v193
    s_add_u32 s52, s101, 2
    s_and_b32 s91, s52, 1
    s_lshl_b32 s91, s91, 5
    s_lshr_b32 s52, s52, 1
    s_sub_u32 s52, s52, s100
    s_and_b32 s54, s52, 1
    s_lshl_b32 s54, s54, 9
    s_lshr_b32 s55, s52, 1
    s_lshl_b32 s55, s55, 13
    s_add_u32 s54, s54, s55
    s_cmp_lt_u32 s52, 4
    s_cselect_b32 s54, s54, 16384
    s_cselect_b64 vcc, -1, 0
    s_add_u32 s54, s54, 36864
    v_cndmask_b32 v194, v218, v220, vcc
    v_xor_b32 v194, s91, v194
    v_add_u32 v194, s54, v194
    s_add_u32 s52, s101, 3
    s_and_b32 s91, s52, 1
    s_lshl_b32 s91, s91, 5
    s_lshr_b32 s52, s52, 1
    s_sub_u32 s52, s52, s100
    s_and_b32 s54, s52, 1
    s_lshl_b32 s54, s54, 9
    s_lshr_b32 s55, s52, 1
    s_lshl_b32 s55, s55, 13
    s_add_u32 s54, s54, s55
    s_cmp_lt_u32 s52, 4
    s_cselect_b32 s54, s54, 16384
    s_cselect_b64 vcc, -1, 0
    s_add_u32 s54, s54, 36864
    v_cndmask_b32 v195, v218, v220, vcc
    v_xor_b32 v195, s91, v195
    v_add_u32 v195, s54, v195
    s_add_u32 s52, s101, 4
    s_and_b32 s91, s52, 1
    s_lshl_b32 s91, s91, 5
    s_lshr_b32 s52, s52, 1
    s_sub_u32 s52, s52, s100
    s_and_b32 s54, s52, 1
    s_lshl_b32 s54, s54, 9
    s_lshr_b32 s55, s52, 1
    s_lshl_b32 s55, s55, 13
    s_add_u32 s54, s54, s55
    s_cmp_lt_u32 s52, 4
    s_cselect_b32 s54, s54, 16384
    s_cselect_b64 vcc, -1, 0
    s_add_u32 s54, s54, 36864
    v_cndmask_b32 v196, v218, v220, vcc
    v_xor_b32 v196, s91, v196
    v_add_u32 v196, s54, v196
    s_mul_i32 s52, s43, 6144
    v_add_u32 v197, s52, v254
    v_bfe_u32 v219, v201, 2, 2
    v_mul_u32_u24 v219, 36864, v219
    v_lshl_add_u32 v219, v217, 6, v219
    v_lshl_add_u32 v200, v216, 4, v219
    s_mul_i32 s52, s43, 27
    s_add_u32 s52, s52, s45
    s_lshl_b32 s5, s52, 8
    s_mul_i32 s52, s43, 9
    s_add_u32 s52, s52, s45
    s_lshl_b32 s4, s52, 9
RL9:
    s_bitcmp1_b32 192, s42
    s_cbranch_scc0 RL10
    v_bfe_u32 v217, v201, 2, 3
    v_lshrrev_b32 v219, 5, v201
    v_mul_u32_u24 v218, 1152, v217
    v_lshl_add_u32 v218, v219, 6, v218
    s_lshl_b32 s52, s100, 6
    v_bfe_u32 v217, v217, 2, 1
    v_lshlrev_b32 v217, 1, v217
    v_xor_b32 v217, v217, v216
    v_lshl_add_u32 v218, v217, 4, v218
    v_add_u32 v224, s52, v218
    v_add_u32 v225, 17408, v224
    v_add_u32 v226, 34816, v224
    v_add_u32 v227, 52224, v224
    v_lshrrev_b32 v217, 2, v201
    v_mul_u32_u24 v218, 1152, v217
    s_lshl_b32 s52, s100, 8
    s_sub_u32 s52, 256, s52
    v_bfe_u32 v217, v217, 2, 1
    v_lshlrev_b32 v217, 1, v217
    v_xor_b32 v217, v217, v216
    v_lshl_add_u32 v218, v217, 4, v218
    v_add_u32 v232, s52, v218
    v_add_u32 v233, 17408, v232
    v_add_u32 v234, 34816, v232
    v_add_u32 v235, 52224, v232
RL10:
    v_add_u32 v228, 129024, v254
    v_and_b32 v229, 0x70, v254
    v_lshlrev_b32 v229, 3, v229
    s_lshl_b32 s91, s42, 6
    v_add_u32 v198, s91, v201
    v_lshlrev_b32 v198, 20, v198
    v_mov_b32 v199, s97
    s_waitcnt lgkmcnt(0)
    s_waitcnt vmcnt(0)
    s_barrier
    buffer_store_dword v199, v198, s[92:95], s90 offen sc1
    s_cmp_eq_u32 s42, 6
    s_cbranch_scc1 OP_LW
    s_cmp_eq_u32 s42, 7
    s_cbranch_scc1 OP_LO
    s_bitcmp1_b32 12, s42
    s_cbranch_scc1 OP_BIG
OP_SML:
    s_mov_b32 s46, 0
    s_mov_b32 s53, 20480
    s_mov_b32 s54, 4294864896
    s_mov_b32 s45, 0
    s_mov_b32 s100, 12288
    s_mov_b32 s101, 4294942720
    s_mov_b32 s44, 0
    s_barrier
    s_add_u32 s36, s14, s6
    s_addc_u32 s37, s15, 0
    s_sub_u32 s38, 1769472, s6
    s_mov_b32 s39, 0x20000
    ds_read_b128 v[72:75], v197 offset:0
    ds_read_b128 v[76:79], v197 offset:2048
    ds_read_b128 v[80:83], v197 offset:4096
    ds_read_b64_tr_b16 v[64:65], v192 offset:0
    ds_read_b64_tr_b16 v[66:67], v192 offset:1024
    ds_read_b64_tr_b16 v[68:69], v193 offset:0
    ds_read_b64_tr_b16 v[70:71], v193 offset:1024
    ds_read_b128 v[92:95], v197 offset:1024
    ds_read_b128 v[96:99], v197 offset:3072
    ds_read_b128 v[100:103], v197 offset:5120
    ds_read_b64_tr_b16 v[84:85], v192 offset:2048
    ds_read_b64_tr_b16 v[86:87], v192 offset:3072
    ds_read_b64_tr_b16 v[88:89], v193 offset:2048
    ds_read_b64_tr_b16 v[90:91], v193 offset:3072
    s_cmp_ge_u32 s46, 102400
    s_cselect_b32 s52, s54, s53
    s_add_u32 s46, s46, s52
    v_add_u32 v192, s52, v192
    v_add_u32 v193, s52, v193
    s_cmp_ge_u32 s45, 24576
    s_cselect_b32 s52, s101, s100
    s_add_u32 s45, s45, s52
    v_add_u32 v197, s52, v197
    s_waitcnt lgkmcnt(0)
    v_mfma_f32_16x16x32_bf16 v[0:3], v[64:67], v[72:75], 0
    ds_read_b128 v[112:115], v197 offset:0
    ds_read_b128 v[116:119], v197 offset:2048
    v_mfma_f32_16x16x32_bf16 v[4:7], v[64:67], v[76:79], 0
    ds_read_b128 v[120:123], v197 offset:4096
    v_mfma_f32_16x16x32_bf16 v[8:11], v[64:67], v[80:83], 0
    ds_read_b64_tr_b16 v[104:105], v192 offset:0
    ds_read_b64_tr_b16 v[106:107], v192 offset:1024
    v_mfma_f32_16x16x32_bf16 v[12:15], v[68:71], v[72:75], 0
    ds_read_b64_tr_b16 v[108:109], v193 offset:0
    v_mfma_f32_16x16x32_bf16 v[16:19], v[68:71], v[76:79], 0
    ds_read_b64_tr_b16 v[110:111], v193 offset:1024
    ds_read_b128 v[132:135], v197 offset:1024
    v_mfma_f32_16x16x32_bf16 v[20:23], v[68:71], v[80:83], 0
    ds_read_b128 v[136:139], v197 offset:3072
    v_mfma_f32_16x16x32_bf16 v[0:3], v[84:87], v[92:95], v[0:3]
    ds_read_b128 v[140:143], v197 offset:5120
    ds_read_b64_tr_b16 v[124:125], v192 offset:2048
    v_mfma_f32_16x16x32_bf16 v[4:7], v[84:87], v[96:99], v[4:7]
    ds_read_b64_tr_b16 v[126:127], v192 offset:3072
    v_mfma_f32_16x16x32_bf16 v[8:11], v[84:87], v[100:103], v[8:11]
    ds_read_b64_tr_b16 v[128:129], v193 offset:2048
    ds_read_b64_tr_b16 v[130:131], v193 offset:3072
    v_mfma_f32_16x16x32_bf16 v[12:15], v[88:91], v[92:95], v[12:15]
    s_cmp_ge_u32 s46, 102400
    s_cselect_b32 s52, s54, s53
    s_add_u32 s46, s46, s52
    v_add_u32 v192, s52, v192
    v_add_u32 v193, s52, v193
    s_cmp_ge_u32 s45, 24576
    s_cselect_b32 s52, s101, s100
    s_add_u32 s45, s45, s52
    v_add_u32 v197, s52, v197
    v_mfma_f32_16x16x32_bf16 v[16:19], v[88:91], v[96:99], v[16:19]
    v_mfma_f32_16x16x32_bf16 v[20:23], v[88:91], v[100:103], v[20:23]
    s_waitcnt lgkmcnt(0)
    v_mfma_f32_16x16x32_bf16 v[0:3], v[104:107], v[112:115], v[0:3]
    v_mfma_f32_16x16x32_bf16 v[4:7], v[104:107], v[116:119], v[4:7]
    v_mfma_f32_16x16x32_bf16 v[8:11], v[104:107], v[120:123], v[8:11]
    v_mfma_f32_16x16x32_bf16 v[12:15], v[108:111], v[112:115], v[12:15]
    v_mfma_f32_16x16x32_bf16 v[16:19], v[108:111], v[116:119], v[16:19]
    v_mfma_f32_16x16x32_bf16 v[20:23], v[108:111], v[120:123], v[20:23]
    v_mfma_f32_16x16x32_bf16 v[0:3], v[124:127], v[132:135], v[0:3]
    v_mfma_f32_16x16x32_bf16 v[4:7], v[124:127], v[136:139], v[4:7]
    v_mfma_f32_16x16x32_bf16 v[8:11], v[124:127], v[140:143], v[8:11]
    v_mfma_f32_16x16x32_bf16 v[12:15], v[128:131], v[132:135], v[12:15]
    v_mfma_f32_16x16x32_bf16 v[16:19], v[128:131], v[136:139], v[16:19]
    v_mfma_f32_16x16x32_bf16 v[20:23], v[128:131], v[140:143], v[20:23]
    s_barrier
    ds_read_b128 v[72:75], v197 offset:0
    ds_read_b128 v[76:79], v197 offset:2048
    ds_read_b128 v[80:83], v197 offset:4096
    ds_read_b64_tr_b16 v[64:65], v192 offset:0
    ds_read_b64_tr_b16 v[66:67], v192 offset:1024
    ds_read_b64_tr_b16 v[68:69], v193 offset:0
    ds_read_b64_tr_b16 v[70:71], v193 offset:1024
    ds_read_b128 v[92:95], v197 offset:1024
    ds_read_b128 v[96:99], v197 offset:3072
    ds_read_b128 v[100:103], v197 offset:5120
    ds_read_b64_tr_b16 v[84:85], v192 offset:2048
    ds_read_b64_tr_b16 v[86:87], v192 offset:3072
    ds_read_b64_tr_b16 v[88:89], v193 offset:2048
    ds_read_b64_tr_b16 v[90:91], v193 offset:3072
    s_cmp_ge_u32 s46, 102400
    s_cselect_b32 s52, s54, s53
    s_add_u32 s46, s46, s52
    v_add_u32 v192, s52, v192
    v_add_u32 v193, s52, v193
    s_cmp_ge_u32 s45, 24576
    s_cselect_b32 s52, s101, s100
    s_add_u32 s45, s45, s52
    v_add_u32 v197, s52, v197
OP_SML_LOOP:
    s_waitcnt lgkmcnt(0)
    s_barrier
    v_mfma_f32_16x16x32_bf16 v[0:3], v[64:67], v[72:75], v[0:3]
    ds_read_b128 v[112:115], v197 offset:0
    ds_read_b128 v[116:119], v197 offset:2048
    v_mfma_f32_16x16x32_bf16 v[4:7], v[64:67], v[76:79], v[4:7]
    ds_read_b128 v[120:123], v197 offset:4096
    v_mfma_f32_16x16x32_bf16 v[8:11], v[64:67], v[80:83], v[8:11]
    ds_read_b64_tr_b16 v[104:105], v192 offset:0
    ds_read_b64_tr_b16 v[106:107], v192 offset:1024
    v_mfma_f32_16x16x32_bf16 v[12:15], v[68:71], v[72:75], v[12:15]
    ds_read_b64_tr_b16 v[108:109], v193 offset:0
    v_mfma_f32_16x16x32_bf16 v[16:19], v[68:71], v[76:79], v[16:19]
    ds_read_b64_tr_b16 v[110:111], v193 offset:1024
    ds_read_b128 v[132:135], v197 offset:1024
    v_mfma_f32_16x16x32_bf16 v[20:23], v[68:71], v[80:83], v[20:23]
    ds_read_b128 v[136:139], v197 offset:3072
    v_mfma_f32_16x16x32_bf16 v[0:3], v[84:87], v[92:95], v[0:3]
    ds_read_b128 v[140:143], v197 offset:5120
    ds_read_b64_tr_b16 v[124:125], v192 offset:2048
    v_mfma_f32_16x16x32_bf16 v[4:7], v[84:87], v[96:99], v[4:7]
    ds_read_b64_tr_b16 v[126:127], v192 offset:3072
    v_mfma_f32_16x16x32_bf16 v[8:11], v[84:87], v[100:103], v[8:11]
    ds_read_b64_tr_b16 v[128:129], v193 offset:2048
    ds_read_b64_tr_b16 v[130:131], v193 offset:3072
    v_mfma_f32_16x16x32_bf16 v[12:15], v[88:91], v[92:95], v[12:15]
    s_cmp_ge_u32 s46, 102400
    s_cselect_b32 s52, s54, s53
    s_add_u32 s46, s46, s52
    v_add_u32 v192, s52, v192
    v_add_u32 v193, s52, v193
    s_cmp_ge_u32 s45, 24576
    s_cselect_b32 s52, s101, s100
    s_add_u32 s45, s45, s52
    v_add_u32 v197, s52, v197
    v_mfma_f32_16x16x32_bf16 v[16:19], v[88:91], v[96:99], v[16:19]
    v_mfma_f32_16x16x32_bf16 v[20:23], v[88:91], v[100:103], v[20:23]
    s_waitcnt lgkmcnt(0)
    s_barrier
    v_mfma_f32_16x16x32_bf16 v[0:3], v[104:107], v[112:115], v[0:3]
    ds_read_b128 v[72:75], v197 offset:0
    ds_read_b128 v[76:79], v197 offset:2048
    v_mfma_f32_16x16x32_bf16 v[4:7], v[104:107], v[116:119], v[4:7]
    ds_read_b128 v[80:83], v197 offset:4096
    v_mfma_f32_16x16x32_bf16 v[8:11], v[104:107], v[120:123], v[8:11]
    ds_read_b64_tr_b16 v[64:65], v192 offset:0
    ds_read_b64_tr_b16 v[66:67], v192 offset:1024
    v_mfma_f32_16x16x32_bf16 v[12:15], v[108:111], v[112:115], v[12:15]
    ds_read_b64_tr_b16 v[68:69], v193 offset:0
    v_mfma_f32_16x16x32_bf16 v[16:19], v[108:111], v[116:119], v[16:19]
    ds_read_b64_tr_b16 v[70:71], v193 offset:1024
    ds_read_b128 v[92:95], v197 offset:1024
    v_mfma_f32_16x16x32_bf16 v[20:23], v[108:111], v[120:123], v[20:23]
    ds_read_b128 v[96:99], v197 offset:3072
    v_mfma_f32_16x16x32_bf16 v[0:3], v[124:127], v[132:135], v[0:3]
    ds_read_b128 v[100:103], v197 offset:5120
    ds_read_b64_tr_b16 v[84:85], v192 offset:2048
    v_mfma_f32_16x16x32_bf16 v[4:7], v[124:127], v[136:139], v[4:7]
    ds_read_b64_tr_b16 v[86:87], v192 offset:3072
    v_mfma_f32_16x16x32_bf16 v[8:11], v[124:127], v[140:143], v[8:11]
    ds_read_b64_tr_b16 v[88:89], v193 offset:2048
    ds_read_b64_tr_b16 v[90:91], v193 offset:3072
    v_mfma_f32_16x16x32_bf16 v[12:15], v[128:131], v[132:135], v[12:15]
    s_cmp_ge_u32 s46, 102400
    s_cselect_b32 s52, s54, s53
    s_add_u32 s46, s46, s52
    v_add_u32 v192, s52, v192
    v_add_u32 v193, s52, v193
    s_cmp_ge_u32 s45, 24576
    s_cselect_b32 s52, s101, s100
    s_add_u32 s45, s45, s52
    v_add_u32 v197, s52, v197
    v_mfma_f32_16x16x32_bf16 v[16:19], v[128:131], v[136:139], v[16:19]
    v_mfma_f32_16x16x32_bf16 v[20:23], v[128:131], v[140:143], v[20:23]
    s_add_u32 s44, s44, 1
    s_cmp_lt_u32 s44, 6
    s_cbranch_scc1 OP_SML_LOOP
    s_waitcnt lgkmcnt(0)
    s_barrier
    v_mfma_f32_16x16x32_bf16 v[0:3], v[64:67], v[72:75], v[0:3]
    ds_read_b128 v[112:115], v197 offset:0
    ds_read_b128 v[116:119], v197 offset:2048
    ds_read_b128 v[120:123], v197 offset:4096
    ds_read_b64_tr_b16 v[104:105], v192 offset:0
    ds_read_b64_tr_b16 v[106:107], v192 offset:1024
    ds_read_b64_tr_b16 v[108:109], v193 offset:0
    v_mfma_f32_16x16x32_bf16 v[4:7], v[64:67], v[76:79], v[4:7]
    ds_read_b64_tr_b16 v[110:111], v193 offset:1024
    ds_read_b128 v[132:135], v197 offset:1024
    ds_read_b128 v[136:139], v197 offset:3072
    ds_read_b128 v[140:143], v197 offset:5120
    ds_read_b64_tr_b16 v[124:125], v192 offset:2048
    v_mfma_f32_16x16x32_bf16 v[8:11], v[64:67], v[80:83], v[8:11]
    ds_read_b64_tr_b16 v[126:127], v192 offset:3072
    ds_read_b64_tr_b16 v[128:129], v193 offset:2048
    ds_read_b64_tr_b16 v[130:131], v193 offset:3072
    s_cmp_ge_u32 s46, 102400
    s_cselect_b32 s52, s54, s53
    s_add_u32 s46, s46, s52
    v_add_u32 v192, s52, v192
    v_add_u32 v193, s52, v193
    s_cmp_ge_u32 s45, 24576
    s_cselect_b32 s52, s101, s100
    s_add_u32 s45, s45, s52
    v_add_u32 v197, s52, v197
    s_mov_b32 s7, 288
    v_mfma_f32_16x16x32_bf16 v[12:15], v[68:71], v[72:75], v[12:15]
    s_lshl_b32 s6, s42, 6
    v_add_u32 v208, s6, v201
    v_cmp_gt_u32 s[8:9], s7, v208
    v_subrev_u32 v209, 32, v208
    v_mov_b32 v215, 0x40000000
    v_cndmask_b32 v208, v209, v208, s[8:9]
    v_mfma_f32_16x16x32_bf16 v[16:19], v[68:71], v[76:79], v[16:19]
    v_lshrrev_b32 v209, 4, v208
    v_and_b32 v210, 15, v208
    v_lshlrev_b32 v210, 4, v210
    v_lshl_add_u32 v248, v209, 9, v210
    v_mul_u32_u24 v212, 57, v209
    v_mfma_f32_16x16x32_bf16 v[20:23], v[68:71], v[80:83], v[20:23]
    v_lshrrev_b32 v212, 9, v212
    v_mul_u32_u24 v213, 18, v212
    v_add_u32 v213, v213, v209
    v_lshl_add_u32 v249, v213, 8, v210
    v_mul_u32_u24 v214, 9, v212
    v_mfma_f32_16x16x32_bf16 v[0:3], v[84:87], v[92:95], v[0:3]
    v_sub_u32 v209, v209, v214
    v_mul_u32_u24 v212, 48, v212
    v_and_b32 v214, 3, v208
    v_add_u32 v212, v212, v214
    v_mul_u32_u24 v212, 1152, v212
    v_lshl_add_u32 v212, v209, 5, v212
    v_mfma_f32_16x16x32_bf16 v[4:7], v[84:87], v[96:99], v[4:7]
    v_bfe_u32 v214, v208, 2, 2
    v_lshl_add_u32 v212, v214, 3, v212
    v_cndmask_b32 v250, v215, v212, s[8:9]
    s_add_u32 s56, s47, 1
    s_and_b32 s56, s56, 3
    v_mfma_f32_16x16x32_bf16 v[8:11], v[84:87], v[100:103], v[8:11]
    s_mul_i32 s56, s56, 9216
    s_add_u32 s57, s47, 2
    s_and_b32 s57, s57, 3
    s_mul_i32 s57, s57, 9216
    s_add_u32 s58, s47, 3
    v_mfma_f32_16x16x32_bf16 v[12:15], v[88:91], v[92:95], v[12:15]
    s_and_b32 s58, s58, 3
    s_mul_i32 s58, s58, 9216
    s_mov_b32 s10, 18432
    s_mov_b32 s11, 36864
    s_mov_b32 s59, 0xffff0000
    v_mfma_f32_16x16x32_bf16 v[16:19], v[88:91], v[96:99], v[16:19]
    v_mfma_f32_16x16x32_bf16 v[20:23], v[88:91], v[100:103], v[20:23]
    s_waitcnt lgkmcnt(0)
    s_barrier
    v_mfma_f32_16x16x32_bf16 v[0:3], v[104:107], v[112:115], v[0:3]
    v_bfe_u32 v204, v201, 2, 2
    v_cmp_eq_u32 vcc, s47, v204
    v_mov_b32 v204, 0x40000000
    v_and_b32 v202, 0xff, v200
    v_cndmask_b32 v200, v200, v204, vcc
    v_lshlrev_b32 v203, 2, v201
    v_add_u32 v203, 16384, v203
    v_add_u32 v202, s5, v202
    v_and_b32 v203, 0xfffffff0, v203
    v_cndmask_b32 v202, v203, v202, vcc
    v_mfma_f32_16x16x32_bf16 v[4:7], v[104:107], v[116:119], v[4:7]
    v_mov_b32 v211, s98
    v_mfma_f32_16x16x32_bf16 v[8:11], v[104:107], v[120:123], v[8:11]
    v_mov_b32 v215, s98
    v_mfma_f32_16x16x32_bf16 v[0:3], v[124:127], v[132:135], v[0:3]
    v_mov_b32 v219, s98
    v_mfma_f32_16x16x32_bf16 v[4:7], v[124:127], v[136:139], v[4:7]
    v_mov_b32 v223, s98
    v_mfma_f32_16x16x32_bf16 v[8:11], v[124:127], v[140:143], v[8:11]
    v_mfma_f32_16x16x32_bf16 v[12:15], v[108:111], v[112:115], v[12:15]
    v_mfma_f32_16x16x32_bf16 v[16:19], v[108:111], v[116:119], v[16:19]
    v_mfma_f32_16x16x32_bf16 v[20:23], v[108:111], v[120:123], v[20:23]
    v_mfma_f32_16x16x32_bf16 v[12:15], v[128:131], v[132:135], v[12:15]
    v_mfma_f32_16x16x32_bf16 v[16:19], v[128:131], v[136:139], v[16:19]
    v_mfma_f32_16x16x32_bf16 v[20:23], v[128:131], v[140:143], v[20:23]
    s_nop 1
    v_cvt_pk_bf16_f32 v208, v0, v1
    v_cvt_pk_bf16_f32 v209, v2, v3
    v_cvt_pk_bf16_f32 v210, v4, v5
    v_cvt_pk_bf16_f32 v212, v6, v7
    v_cvt_pk_bf16_f32 v213, v8, v9
    v_cvt_pk_bf16_f32 v214, v10, v11
    buffer_store_dwordx4 v[208:211], v200, s[28:31], s4 offen offset:0 sc1
    buffer_store_dwordx4 v[212:215], v200, s[28:31], s4 offen offset:256 sc1
    ds_write_b128 v202, v[0:3] offset:0
    ds_write_b128 v202, v[4:7] offset:2304
    ds_write_b128 v202, v[8:11] offset:4608
    v_cvt_pk_bf16_f32 v216, v12, v13
    v_cvt_pk_bf16_f32 v217, v14, v15
    v_cvt_pk_bf16_f32 v218, v16, v17
    v_cvt_pk_bf16_f32 v220, v18, v19
    v_cvt_pk_bf16_f32 v221, v20, v21
    v_cvt_pk_bf16_f32 v222, v22, v23
    buffer_store_dwordx4 v[216:219], v200, s[28:31], s4 offen offset:512 sc1
    buffer_store_dwordx4 v[220:223], v200, s[28:31], s4 offen offset:768 sc1
    ds_write_b128 v202, v[12:15] offset:256
    ds_write_b128 v202, v[16:19] offset:2560
    ds_write_b128 v202, v[20:23] offset:4864
    s_branch OP_FIN
OP_BIG:
    s_mov_b32 s46, 0
    s_mov_b32 s53, 20480
    s_mov_b32 s54, 4294864896
    s_mov_b32 s45, 0
    s_mov_b32 s100, 12288
    s_mov_b32 s101, 4294942720
    s_mov_b32 s44, 0
    s_barrier
    s_add_u32 s36, s14, s6
    s_addc_u32 s37, s15, 0
    s_sub_u32 s38, 1769472, s6
    s_mov_b32 s39, 0x20000
    ds_read_b128 v[84:87], v197 offset:0
    ds_read_b128 v[88:91], v197 offset:2048
    ds_read_b128 v[92:95], v197 offset:4096
    ds_read_b64_tr_b16 v[64:65], v192 offset:0
    ds_read_b64_tr_b16 v[66:67], v192 offset:1024
    ds_read_b64_tr_b16 v[68:69], v193 offset:0
    ds_read_b64_tr_b16 v[70:71], v193 offset:1024
    ds_read_b64_tr_b16 v[72:73], v194 offset:0
    ds_read_b64_tr_b16 v[74:75], v194 offset:1024
    ds_read_b64_tr_b16 v[76:77], v195 offset:0
    ds_read_b64_tr_b16 v[78:79], v195 offset:1024
    ds_read_b64_tr_b16 v[80:81], v196 offset:0
    ds_read_b64_tr_b16 v[82:83], v196 offset:1024
    ds_read_b128 v[116:119], v197 offset:1024
    ds_read_b128 v[120:123], v197 offset:3072
    ds_read_b128 v[124:127], v197 offset:5120
    ds_read_b64_tr_b16 v[96:97], v192 offset:2048
    ds_read_b64_tr_b16 v[98:99], v192 offset:3072
    ds_read_b64_tr_b16 v[100:101], v193 offset:2048
    ds_read_b64_tr_b16 v[102:103], v193 offset:3072
    ds_read_b64_tr_b16 v[104:105], v194 offset:2048
    ds_read_b64_tr_b16 v[106:107], v194 offset:3072
    ds_read_b64_tr_b16 v[108:109], v195 offset:2048
    ds_read_b64_tr_b16 v[110:111], v195 offset:3072
    ds_read_b64_tr_b16 v[112:113], v196 offset:2048
    ds_read_b64_tr_b16 v[114:115], v196 offset:3072
    s_cmp_ge_u32 s46, 102400
    s_cselect_b32 s52, s54, s53
    s_add_u32 s46, s46, s52
    v_add_u32 v192, s52, v192
    v_add_u32 v193, s52, v193
    v_add_u32 v194, s52, v194
    v_add_u32 v195, s52, v195
    v_add_u32 v196, s52, v196
    s_cmp_ge_u32 s45, 24576
    s_cselect_b32 s52, s101, s100
    s_add_u32 s45, s45, s52
    v_add_u32 v197, s52, v197
    s_waitcnt lgkmcnt(0)
    v_mfma_f32_16x16x32_bf16 v[0:3], v[64:67], v[84:87], 0
    ds_read_b128 v[148:151], v197 offset:0
    v_mfma_f32_16x16x32_bf16 v[4:7], v[64:67], v[88:91], 0
    ds_read_b128 v[152:155], v197 offset:2048
    v_mfma_f32_16x16x32_bf16 v[8:11], v[64:67], v[92:95], 0
    ds_read_b128 v[156:159], v197 offset:4096
    v_mfma_f32_16x16x32_bf16 v[12:15], v[68:71], v[84:87], 0
    ds_read_b64_tr_b16 v[128:129], v192 offset:0
    v_mfma_f32_16x16x32_bf16 v[16:19], v[68:71], v[88:91], 0
    ds_read_b64_tr_b16 v[130:131], v192 offset:1024
    v_mfma_f32_16x16x32_bf16 v[20:23], v[68:71], v[92:95], 0
    ds_read_b64_tr_b16 v[132:133], v193 offset:0
    v_mfma_f32_16x16x32_bf16 v[24:27], v[72:75], v[84:87], 0
    ds_read_b64_tr_b16 v[134:135], v193 offset:1024
    v_mfma_f32_16x16x32_bf16 v[28:31], v[72:75], v[88:91], 0
    ds_read_b64_tr_b16 v[136:137], v194 offset:0
    v_mfma_f32_16x16x32_bf16 v[32:35], v[72:75], v[92:95], 0
    ds_read_b64_tr_b16 v[138:139], v194 offset:1024
    v_mfma_f32_16x16x32_bf16 v[36:39], v[76:79], v[84:87], 0
    ds_read_b64_tr_b16 v[140:141], v195 offset:0
    v_mfma_f32_16x16x32_bf16 v[40:43], v[76:79], v[88:91], 0
    ds_read_b64_tr_b16 v[142:143], v195 offset:1024
    v_mfma_f32_16x16x32_bf16 v[44:47], v[76:79], v[92:95], 0
    ds_read_b64_tr_b16 v[144:145], v196 offset:0
    v_mfma_f32_16x16x32_bf16 v[48:51], v[80:83], v[84:87], 0
    ds_read_b64_tr_b16 v[146:147], v196 offset:1024
    v_mfma_f32_16x16x32_bf16 v[52:55], v[80:83], v[88:91], 0
    ds_read_b128 v[180:183], v197 offset:1024
    v_mfma_f32_16x16x32_bf16 v[56:59], v[80:83], v[92:95], 0
    ds_read_b128 v[184:187], v197 offset:3072
    v_mfma_f32_16x16x32_bf16 v[0:3], v[96:99], v[116:119], v[0:3]
    ds_read_b128 v[188:191], v197 offset:5120
    v_mfma_f32_16x16x32_bf16 v[4:7], v[96:99], v[120:123], v[4:7]
    ds_read_b64_tr_b16 v[160:161], v192 offset:2048
    v_mfma_f32_16x16x32_bf16 v[8:11], v[96:99], v[124:127], v[8:11]
    ds_read_b64_tr_b16 v[162:163], v192 offset:3072
    v_mfma_f32_16x16x32_bf16 v[12:15], v[100:103], v[116:119], v[12:15]
    ds_read_b64_tr_b16 v[164:165], v193 offset:2048
    v_mfma_f32_16x16x32_bf16 v[16:19], v[100:103], v[120:123], v[16:19]
    ds_read_b64_tr_b16 v[166:167], v193 offset:3072
    v_mfma_f32_16x16x32_bf16 v[20:23], v[100:103], v[124:127], v[20:23]
    ds_read_b64_tr_b16 v[168:169], v194 offset:2048
    v_mfma_f32_16x16x32_bf16 v[24:27], v[104:107], v[116:119], v[24:27]
    ds_read_b64_tr_b16 v[170:171], v194 offset:3072
    v_mfma_f32_16x16x32_bf16 v[28:31], v[104:107], v[120:123], v[28:31]
    ds_read_b64_tr_b16 v[172:173], v195 offset:2048
    v_mfma_f32_16x16x32_bf16 v[32:35], v[104:107], v[124:127], v[32:35]
    ds_read_b64_tr_b16 v[174:175], v195 offset:3072
    v_mfma_f32_16x16x32_bf16 v[36:39], v[108:111], v[116:119], v[36:39]
    ds_read_b64_tr_b16 v[176:177], v196 offset:2048
    v_mfma_f32_16x16x32_bf16 v[40:43], v[108:111], v[120:123], v[40:43]
    ds_read_b64_tr_b16 v[178:179], v196 offset:3072
    v_mfma_f32_16x16x32_bf16 v[44:47], v[108:111], v[124:127], v[44:47]
    s_cmp_ge_u32 s46, 102400
    s_cselect_b32 s52, s54, s53
    s_add_u32 s46, s46, s52
    v_add_u32 v192, s52, v192
    v_add_u32 v193, s52, v193
    v_add_u32 v194, s52, v194
    v_add_u32 v195, s52, v195
    v_add_u32 v196, s52, v196
    s_cmp_ge_u32 s45, 24576
    s_cselect_b32 s52, s101, s100
    s_add_u32 s45, s45, s52
    v_add_u32 v197, s52, v197
    v_mfma_f32_16x16x32_bf16 v[48:51], v[112:115], v[116:119], v[48:51]
    v_mfma_f32_16x16x32_bf16 v[52:55], v[112:115], v[120:123], v[52:55]
    v_mfma_f32_16x16x32_bf16 v[56:59], v[112:115], v[124:127], v[56:59]
    s_waitcnt lgkmcnt(0)
    v_mfma_f32_16x16x32_bf16 v[0:3], v[128:131], v[148:151], v[0:3]
    v_mfma_f32_16x16x32_bf16 v[4:7], v[128:131], v[152:155], v[4:7]
    v_mfma_f32_16x16x32_bf16 v[8:11], v[128:131], v[156:159], v[8:11]
    v_mfma_f32_16x16x32_bf16 v[12:15], v[132:135], v[148:151], v[12:15]
    v_mfma_f32_16x16x32_bf16 v[16:19], v[132:135], v[152:155], v[16:19]
    v_mfma_f32_16x16x32_bf16 v[20:23], v[132:135], v[156:159], v[20:23]
    v_mfma_f32_16x16x32_bf16 v[24:27], v[136:139], v[148:151], v[24:27]
    v_mfma_f32_16x16x32_bf16 v[28:31], v[136:139], v[152:155], v[28:31]
    v_mfma_f32_16x16x32_bf16 v[32:35], v[136:139], v[156:159], v[32:35]
    v_mfma_f32_16x16x32_bf16 v[36:39], v[140:143], v[148:151], v[36:39]
    v_mfma_f32_16x16x32_bf16 v[40:43], v[140:143], v[152:155], v[40:43]
    v_mfma_f32_16x16x32_bf16 v[44:47], v[140:143], v[156:159], v[44:47]
    v_mfma_f32_16x16x32_bf16 v[48:51], v[144:147], v[148:151], v[48:51]
    v_mfma_f32_16x16x32_bf16 v[52:55], v[144:147], v[152:155], v[52:55]
    v_mfma_f32_16x16x32_bf16 v[56:59], v[144:147], v[156:159], v[56:59]
    v_mfma_f32_16x16x32_bf16 v[0:3], v[160:163], v[180:183], v[0:3]
    v_mfma_f32_16x16x32_bf16 v[4:7], v[160:163], v[184:187], v[4:7]
    v_mfma_f32_16x16x32_bf16 v[8:11], v[160:163], v[188:191], v[8:11]
    v_mfma_f32_16x16x32_bf16 v[12:15], v[164:167], v[180:183], v[12:15]
    v_mfma_f32_16x16x32_bf16 v[16:19], v[164:167], v[184:187], v[16:19]
    v_mfma_f32_16x16x32_bf16 v[20:23], v[164:167], v[188:191], v[20:23]
    v_mfma_f32_16x16x32_bf16 v[24:27], v[168:171], v[180:183], v[24:27]
    v_mfma_f32_16x16x32_bf16 v[28:31], v[168:171], v[184:187], v[28:31]
    v_mfma_f32_16x16x32_bf16 v[32:35], v[168:171], v[188:191], v[32:35]
    v_mfma_f32_16x16x32_bf16 v[36:39], v[172:175], v[180:183], v[36:39]
    v_mfma_f32_16x16x32_bf16 v[40:43], v[172:175], v[184:187], v[40:43]
    v_mfma_f32_16x16x32_bf16 v[44:47], v[172:175], v[188:191], v[44:47]
    v_mfma_f32_16x16x32_bf16 v[48:51], v[176:179], v[180:183], v[48:51]
    v_mfma_f32_16x16x32_bf16 v[52:55], v[176:179], v[184:187], v[52:55]
    v_mfma_f32_16x16x32_bf16 v[56:59], v[176:179], v[188:191], v[56:59]
    s_barrier
    ds_read_b128 v[84:87], v197 offset:0
    ds_read_b128 v[88:91], v197 offset:2048
    ds_read_b128 v[92:95], v197 offset:4096
    ds_read_b64_tr_b16 v[64:65], v192 offset:0
    ds_read_b64_tr_b16 v[66:67], v192 offset:1024
    ds_read_b64_tr_b16 v[68:69], v193 offset:0
    ds_read_b64_tr_b16 v[70:71], v193 offset:1024
    ds_read_b64_tr_b16 v[72:73], v194 offset:0
    ds_read_b64_tr_b16 v[74:75], v194 offset:1024
    ds_read_b64_tr_b16 v[76:77], v195 offset:0
    ds_read_b64_tr_b16 v[78:79], v195 offset:1024
    ds_read_b64_tr_b16 v[80:81], v196 offset:0
    ds_read_b64_tr_b16 v[82:83], v196 offset:1024
    ds_read_b128 v[116:119], v197 offset:1024
    ds_read_b128 v[120:123], v197 offset:3072
    ds_read_b128 v[124:127], v197 offset:5120
    ds_read_b64_tr_b16 v[96:97], v192 offset:2048
    ds_read_b64_tr_b16 v[98:99], v192 offset:3072
    ds_read_b64_tr_b16 v[100:101], v193 offset:2048
    ds_read_b64_tr_b16 v[102:103], v193 offset:3072
    ds_read_b64_tr_b16 v[104:105], v194 offset:2048
    ds_read_b64_tr_b16 v[106:107], v194 offset:3072
    ds_read_b64_tr_b16 v[108:109], v195 offset:2048
    ds_read_b64_tr_b16 v[110:111], v195 offset:3072
    ds_read_b64_tr_b16 v[112:113], v196 offset:2048
    ds_read_b64_tr_b16 v[114:115], v196 offset:3072
    s_cmp_ge_u32 s46, 102400
    s_cselect_b32 s52, s54, s53
    s_add_u32 s46, s46, s52
    v_add_u32 v192, s52, v192
    v_add_u32 v193, s52, v193
    v_add_u32 v194, s52, v194
    v_add_u32 v195, s52, v195
    v_add_u32 v196, s52, v196
    s_cmp_ge_u32 s45, 24576
    s_cselect_b32 s52, s101, s100
    s_add_u32 s45, s45, s52
    v_add_u32 v197, s52, v197
OP_BIG_LOOP:
    s_waitcnt lgkmcnt(0)
    s_barrier
    v_mfma_f32_16x16x32_bf16 v[0:3], v[64:67], v[84:87], v[0:3]
    ds_read_b128 v[148:151], v197 offset:0
    v_mfma_f32_16x16x32_bf16 v[4:7], v[64:67], v[88:91], v[4:7]
    ds_read_b128 v[152:155], v197 offset:2048
    v_mfma_f32_16x16x32_bf16 v[8:11], v[64:67], v[92:95], v[8:11]
    ds_read_b128 v[156:159], v197 offset:4096
    v_mfma_f32_16x16x32_bf16 v[12:15], v[68:71], v[84:87], v[12:15]
    ds_read_b64_tr_b16 v[128:129], v192 offset:0
    v_mfma_f32_16x16x32_bf16 v[16:19], v[68:71], v[88:91], v[16:19]
    ds_read_b64_tr_b16 v[130:131], v192 offset:1024
    v_mfma_f32_16x16x32_bf16 v[20:23], v[68:71], v[92:95], v[20:23]
    ds_read_b64_tr_b16 v[132:133], v193 offset:0
    v_mfma_f32_16x16x32_bf16 v[24:27], v[72:75], v[84:87], v[24:27]
    ds_read_b64_tr_b16 v[134:135], v193 offset:1024
    v_mfma_f32_16x16x32_bf16 v[28:31], v[72:75], v[88:91], v[28:31]
    ds_read_b64_tr_b16 v[136:137], v194 offset:0
    v_mfma_f32_16x16x32_bf16 v[32:35], v[72:75], v[92:95], v[32:35]
    ds_read_b64_tr_b16 v[138:139], v194 offset:1024
    v_mfma_f32_16x16x32_bf16 v[36:39], v[76:79], v[84:87], v[36:39]
    ds_read_b64_tr_b16 v[140:141], v195 offset:0
    v_mfma_f32_16x16x32_bf16 v[40:43], v[76:79], v[88:91], v[40:43]
    ds_read_b64_tr_b16 v[142:143], v195 offset:1024
    v_mfma_f32_16x16x32_bf16 v[44:47], v[76:79], v[92:95], v[44:47]
    ds_read_b64_tr_b16 v[144:145], v196 offset:0
    v_mfma_f32_16x16x32_bf16 v[48:51], v[80:83], v[84:87], v[48:51]
    ds_read_b64_tr_b16 v[146:147], v196 offset:1024
    v_mfma_f32_16x16x32_bf16 v[52:55], v[80:83], v[88:91], v[52:55]
    ds_read_b128 v[180:183], v197 offset:1024
    v_mfma_f32_16x16x32_bf16 v[56:59], v[80:83], v[92:95], v[56:59]
    ds_read_b128 v[184:187], v197 offset:3072
    v_mfma_f32_16x16x32_bf16 v[0:3], v[96:99], v[116:119], v[0:3]
    ds_read_b128 v[188:191], v197 offset:5120
    v_mfma_f32_16x16x32_bf16 v[4:7], v[96:99], v[120:123], v[4:7]
    ds_read_b64_tr_b16 v[160:161], v192 offset:2048
    v_mfma_f32_16x16x32_bf16 v[8:11], v[96:99], v[124:127], v[8:11]
    ds_read_b64_tr_b16 v[162:163], v192 offset:3072
    v_mfma_f32_16x16x32_bf16 v[12:15], v[100:103], v[116:119], v[12:15]
    ds_read_b64_tr_b16 v[164:165], v193 offset:2048
    v_mfma_f32_16x16x32_bf16 v[16:19], v[100:103], v[120:123], v[16:19]
    ds_read_b64_tr_b16 v[166:167], v193 offset:3072
    v_mfma_f32_16x16x32_bf16 v[20:23], v[100:103], v[124:127], v[20:23]
    ds_read_b64_tr_b16 v[168:169], v194 offset:2048
    v_mfma_f32_16x16x32_bf16 v[24:27], v[104:107], v[116:119], v[24:27]
    ds_read_b64_tr_b16 v[170:171], v194 offset:3072
    v_mfma_f32_16x16x32_bf16 v[28:31], v[104:107], v[120:123], v[28:31]
    ds_read_b64_tr_b16 v[172:173], v195 offset:2048
    v_mfma_f32_16x16x32_bf16 v[32:35], v[104:107], v[124:127], v[32:35]
    ds_read_b64_tr_b16 v[174:175], v195 offset:3072
    v_mfma_f32_16x16x32_bf16 v[36:39], v[108:111], v[116:119], v[36:39]
    ds_read_b64_tr_b16 v[176:177], v196 offset:2048
    v_mfma_f32_16x16x32_bf16 v[40:43], v[108:111], v[120:123], v[40:43]
    ds_read_b64_tr_b16 v[178:179], v196 offset:3072
    v_mfma_f32_16x16x32_bf16 v[44:47], v[108:111], v[124:127], v[44:47]
    s_cmp_ge_u32 s46, 102400
    s_cselect_b32 s52, s54, s53
    s_add_u32 s46, s46, s52
    v_add_u32 v192, s52, v192
    v_add_u32 v193, s52, v193
    v_add_u32 v194, s52, v194
    v_add_u32 v195, s52, v195
    v_add_u32 v196, s52, v196
    s_cmp_ge_u32 s45, 24576
    s_cselect_b32 s52, s101, s100
    s_add_u32 s45, s45, s52
    v_add_u32 v197, s52, v197
    v_mfma_f32_16x16x32_bf16 v[48:51], v[112:115], v[116:119], v[48:51]
    v_mfma_f32_16x16x32_bf16 v[52:55], v[112:115], v[120:123], v[52:55]
    v_mfma_f32_16x16x32_bf16 v[56:59], v[112:115], v[124:127], v[56:59]
    s_waitcnt lgkmcnt(0)
    s_barrier
    v_mfma_f32_16x16x32_bf16 v[0:3], v[128:131], v[148:151], v[0:3]
    ds_read_b128 v[84:87], v197 offset:0
    v_mfma_f32_16x16x32_bf16 v[4:7], v[128:131], v[152:155], v[4:7]
    ds_read_b128 v[88:91], v197 offset:2048
    v_mfma_f32_16x16x32_bf16 v[8:11], v[128:131], v[156:159], v[8:11]
    ds_read_b128 v[92:95], v197 offset:4096
    v_mfma_f32_16x16x32_bf16 v[12:15], v[132:135], v[148:151], v[12:15]
    ds_read_b64_tr_b16 v[64:65], v192 offset:0
    v_mfma_f32_16x16x32_bf16 v[16:19], v[132:135], v[152:155], v[16:19]
    ds_read_b64_tr_b16 v[66:67], v192 offset:1024
    v_mfma_f32_16x16x32_bf16 v[20:23], v[132:135], v[156:159], v[20:23]
    ds_read_b64_tr_b16 v[68:69], v193 offset:0
    v_mfma_f32_16x16x32_bf16 v[24:27], v[136:139], v[148:151], v[24:27]
    ds_read_b64_tr_b16 v[70:71], v193 offset:1024
    v_mfma_f32_16x16x32_bf16 v[28:31], v[136:139], v[152:155], v[28:31]
    ds_read_b64_tr_b16 v[72:73], v194 offset:0
    v_mfma_f32_16x16x32_bf16 v[32:35], v[136:139], v[156:159], v[32:35]
    ds_read_b64_tr_b16 v[74:75], v194 offset:1024
    v_mfma_f32_16x16x32_bf16 v[36:39], v[140:143], v[148:151], v[36:39]
    ds_read_b64_tr_b16 v[76:77], v195 offset:0
    v_mfma_f32_16x16x32_bf16 v[40:43], v[140:143], v[152:155], v[40:43]
    ds_read_b64_tr_b16 v[78:79], v195 offset:1024
    v_mfma_f32_16x16x32_bf16 v[44:47], v[140:143], v[156:159], v[44:47]
    ds_read_b64_tr_b16 v[80:81], v196 offset:0
    v_mfma_f32_16x16x32_bf16 v[48:51], v[144:147], v[148:151], v[48:51]
    ds_read_b64_tr_b16 v[82:83], v196 offset:1024
    v_mfma_f32_16x16x32_bf16 v[52:55], v[144:147], v[152:155], v[52:55]
    ds_read_b128 v[116:119], v197 offset:1024
    v_mfma_f32_16x16x32_bf16 v[56:59], v[144:147], v[156:159], v[56:59]
    ds_read_b128 v[120:123], v197 offset:3072
    v_mfma_f32_16x16x32_bf16 v[0:3], v[160:163], v[180:183], v[0:3]
    ds_read_b128 v[124:127], v197 offset:5120
    v_mfma_f32_16x16x32_bf16 v[4:7], v[160:163], v[184:187], v[4:7]
    ds_read_b64_tr_b16 v[96:97], v192 offset:2048
    v_mfma_f32_16x16x32_bf16 v[8:11], v[160:163], v[188:191], v[8:11]
    ds_read_b64_tr_b16 v[98:99], v192 offset:3072
    v_mfma_f32_16x16x32_bf16 v[12:15], v[164:167], v[180:183], v[12:15]
    ds_read_b64_tr_b16 v[100:101], v193 offset:2048
    v_mfma_f32_16x16x32_bf16 v[16:19], v[164:167], v[184:187], v[16:19]
    ds_read_b64_tr_b16 v[102:103], v193 offset:3072
    v_mfma_f32_16x16x32_bf16 v[20:23], v[164:167], v[188:191], v[20:23]
    ds_read_b64_tr_b16 v[104:105], v194 offset:2048
    v_mfma_f32_16x16x32_bf16 v[24:27], v[168:171], v[180:183], v[24:27]
    ds_read_b64_tr_b16 v[106:107], v194 offset:3072
    v_mfma_f32_16x16x32_bf16 v[28:31], v[168:171], v[184:187], v[28:31]
    ds_read_b64_tr_b16 v[108:109], v195 offset:2048
    v_mfma_f32_16x16x32_bf16 v[32:35], v[168:171], v[188:191], v[32:35]
    ds_read_b64_tr_b16 v[110:111], v195 offset:3072
    v_mfma_f32_16x16x32_bf16 v[36:39], v[172:175], v[180:183], v[36:39]
    ds_read_b64_tr_b16 v[112:113], v196 offset:2048
    v_mfma_f32_16x16x32_bf16 v[40:43], v[172:175], v[184:187], v[40:43]
    ds_read_b64_tr_b16 v[114:115], v196 offset:3072
    v_mfma_f32_16x16x32_bf16 v[44:47], v[172:175], v[188:191], v[44:47]
    s_cmp_ge_u32 s46, 102400
    s_cselect_b32 s52, s54, s53
    s_add_u32 s46, s46, s52
    v_add_u32 v192, s52, v192
    v_add_u32 v193, s52, v193
    v_add_u32 v194, s52, v194
    v_add_u32 v195, s52, v195
    v_add_u32 v196, s52, v196
    s_cmp_ge_u32 s45, 24576
    s_cselect_b32 s52, s101, s100
    s_add_u32 s45, s45, s52
    v_add_u32 v197, s52, v197
    v_mfma_f32_16x16x32_bf16 v[48:51], v[176:179], v[180:183], v[48:51]
    v_mfma_f32_16x16x32_bf16 v[52:55], v[176:179], v[184:187], v[52:55]
    v_mfma_f32_16x16x32_bf16 v[56:59], v[176:179], v[188:191], v[56:59]
    s_add_u32 s44, s44, 1
    s_cmp_lt_u32 s44, 6
    s_cbranch_scc1 OP_BIG_LOOP
    s_waitcnt lgkmcnt(0)
    s_barrier
    v_mfma_f32_16x16x32_bf16 v[0:3], v[64:67], v[84:87], v[0:3]
    ds_read_b128 v[148:151], v197 offset:0
    ds_read_b128 v[152:155], v197 offset:2048
    ds_read_b128 v[156:159], v197 offset:4096
    v_mfma_f32_16x16x32_bf16 v[4:7], v[64:67], v[88:91], v[4:7]
    ds_read_b64_tr_b16 v[128:129], v192 offset:0
    ds_read_b64_tr_b16 v[130:131], v192 offset:1024
    v_mfma_f32_16x16x32_bf16 v[8:11], v[64:67], v[92:95], v[8:11]
    ds_read_b64_tr_b16 v[132:133], v193 offset:0
    ds_read_b64_tr_b16 v[134:135], v193 offset:1024
    v_mfma_f32_16x16x32_bf16 v[12:15], v[68:71], v[84:87], v[12:15]
    ds_read_b64_tr_b16 v[136:137], v194 offset:0
    ds_read_b64_tr_b16 v[138:139], v194 offset:1024
    ds_read_b64_tr_b16 v[140:141], v195 offset:0
    v_mfma_f32_16x16x32_bf16 v[16:19], v[68:71], v[88:91], v[16:19]
    ds_read_b64_tr_b16 v[142:143], v195 offset:1024
    ds_read_b64_tr_b16 v[144:145], v196 offset:0
    v_mfma_f32_16x16x32_bf16 v[20:23], v[68:71], v[92:95], v[20:23]
    ds_read_b64_tr_b16 v[146:147], v196 offset:1024
    ds_read_b128 v[180:183], v197 offset:1024
    v_mfma_f32_16x16x32_bf16 v[24:27], v[72:75], v[84:87], v[24:27]
    ds_read_b128 v[184:187], v197 offset:3072
    ds_read_b128 v[188:191], v197 offset:5120
    ds_read_b64_tr_b16 v[160:161], v192 offset:2048
    v_mfma_f32_16x16x32_bf16 v[28:31], v[72:75], v[88:91], v[28:31]
    ds_read_b64_tr_b16 v[162:163], v192 offset:3072
    ds_read_b64_tr_b16 v[164:165], v193 offset:2048
    v_mfma_f32_16x16x32_bf16 v[32:35], v[72:75], v[92:95], v[32:35]
    ds_read_b64_tr_b16 v[166:167], v193 offset:3072
    ds_read_b64_tr_b16 v[168:169], v194 offset:2048
    v_mfma_f32_16x16x32_bf16 v[36:39], v[76:79], v[84:87], v[36:39]
    ds_read_b64_tr_b16 v[170:171], v194 offset:3072
    ds_read_b64_tr_b16 v[172:173], v195 offset:2048
    ds_read_b64_tr_b16 v[174:175], v195 offset:3072
    v_mfma_f32_16x16x32_bf16 v[40:43], v[76:79], v[88:91], v[40:43]
    ds_read_b64_tr_b16 v[176:177], v196 offset:2048
    ds_read_b64_tr_b16 v[178:179], v196 offset:3072
    v_mfma_f32_16x16x32_bf16 v[44:47], v[76:79], v[92:95], v[44:47]
    s_cmp_ge_u32 s46, 102400
    s_cselect_b32 s52, s54, s53
    s_add_u32 s46, s46, s52
    v_add_u32 v192, s52, v192
    v_add_u32 v193, s52, v193
    v_add_u32 v194, s52, v194
    v_add_u32 v195, s52, v195
    v_add_u32 v196, s52, v196
    s_cmp_ge_u32 s45, 24576
    s_cselect_b32 s52, s101, s100
    s_add_u32 s45, s45, s52
    v_add_u32 v197, s52, v197
    s_mov_b32 s7, 288
    v_mfma_f32_16x16x32_bf16 v[48:51], v[80:83], v[84:87], v[48:51]
    s_lshl_b32 s6, s42, 6
    v_add_u32 v208, s6, v201
    v_cmp_gt_u32 s[8:9], s7, v208
    v_mfma_f32_16x16x32_bf16 v[52:55], v[80:83], v[88:91], v[52:55]
    v_subrev_u32 v209, 32, v208
    v_mov_b32 v215, 0x40000000
    v_mfma_f32_16x16x32_bf16 v[56:59], v[80:83], v[92:95], v[56:59]
    v_cndmask_b32 v208, v209, v208, s[8:9]
    v_lshrrev_b32 v209, 4, v208
    v_mfma_f32_16x16x32_bf16 v[0:3], v[96:99], v[116:119], v[0:3]
    v_and_b32 v210, 15, v208
    v_lshlrev_b32 v210, 4, v210
    v_lshl_add_u32 v248, v209, 9, v210
    v_mfma_f32_16x16x32_bf16 v[4:7], v[96:99], v[120:123], v[4:7]
    v_mul_u32_u24 v212, 57, v209
    v_lshrrev_b32 v212, 9, v212
    v_mfma_f32_16x16x32_bf16 v[8:11], v[96:99], v[124:127], v[8:11]
    v_mul_u32_u24 v213, 18, v212
    v_add_u32 v213, v213, v209
    v_mfma_f32_16x16x32_bf16 v[12:15], v[100:103], v[116:119], v[12:15]
    v_lshl_add_u32 v249, v213, 8, v210
    v_mul_u32_u24 v214, 9, v212
    v_sub_u32 v209, v209, v214
    v_mfma_f32_16x16x32_bf16 v[16:19], v[100:103], v[120:123], v[16:19]
    v_mul_u32_u24 v212, 48, v212
    v_and_b32 v214, 3, v208
    v_mfma_f32_16x16x32_bf16 v[20:23], v[100:103], v[124:127], v[20:23]
    v_add_u32 v212, v212, v214
    v_mul_u32_u24 v212, 1152, v212
    v_mfma_f32_16x16x32_bf16 v[24:27], v[104:107], v[116:119], v[24:27]
    v_lshl_add_u32 v212, v209, 5, v212
    v_bfe_u32 v214, v208, 2, 2
    v_lshl_add_u32 v212, v214, 3, v212
    v_mfma_f32_16x16x32_bf16 v[28:31], v[104:107], v[120:123], v[28:31]
    v_cndmask_b32 v250, v215, v212, s[8:9]
    s_add_u32 s56, s47, 1
    v_mfma_f32_16x16x32_bf16 v[32:35], v[104:107], v[124:127], v[32:35]
    s_and_b32 s56, s56, 3
    s_mul_i32 s56, s56, 9216
    v_mfma_f32_16x16x32_bf16 v[36:39], v[108:111], v[116:119], v[36:39]
    s_add_u32 s57, s47, 2
    s_and_b32 s57, s57, 3
    s_mul_i32 s57, s57, 9216
    v_mfma_f32_16x16x32_bf16 v[40:43], v[108:111], v[120:123], v[40:43]
    s_add_u32 s58, s47, 3
    s_and_b32 s58, s58, 3
    v_mfma_f32_16x16x32_bf16 v[44:47], v[108:111], v[124:127], v[44:47]
    s_mul_i32 s58, s58, 9216
    s_mov_b32 s10, 18432
    v_mfma_f32_16x16x32_bf16 v[48:51], v[112:115], v[116:119], v[48:51]
    s_mov_b32 s11, 36864
    s_mov_b32 s59, 0xffff0000
    v_mfma_f32_16x16x32_bf16 v[52:55], v[112:115], v[120:123], v[52:55]
    v_mfma_f32_16x16x32_bf16 v[56:59], v[112:115], v[124:127], v[56:59]
    s_waitcnt lgkmcnt(0)
    s_barrier
    v_mfma_f32_16x16x32_bf16 v[0:3], v[128:131], v[148:151], v[0:3]
    v_bfe_u32 v204, v201, 2, 2
    v_cmp_eq_u32 vcc, s47, v204
    v_mov_b32 v204, 0x40000000
    v_and_b32 v202, 0xff, v200
    v_cndmask_b32 v200, v200, v204, vcc
    v_lshlrev_b32 v203, 2, v201
    v_add_u32 v203, 16384, v203
    v_add_u32 v202, s5, v202
    v_and_b32 v203, 0xfffffff0, v203
    v_cndmask_b32 v202, v203, v202, vcc
    v_mov_b32 v211, s98
    v_mfma_f32_16x16x32_bf16 v[4:7], v[128:131], v[152:155], v[4:7]
    v_mov_b32 v215, s98
    v_mov_b32 v219, s98
    v_mfma_f32_16x16x32_bf16 v[8:11], v[128:131], v[156:159], v[8:11]
    v_mov_b32 v223, s98
    v_mov_b32 v227, s98
    v_mfma_f32_16x16x32_bf16 v[0:3], v[160:163], v[180:183], v[0:3]
    v_mov_b32 v231, s98
    v_mov_b32 v235, s98
    v_mfma_f32_16x16x32_bf16 v[4:7], v[160:163], v[184:187], v[4:7]
    v_mov_b32 v239, s98
    v_mov_b32 v243, s98
    v_mfma_f32_16x16x32_bf16 v[8:11], v[160:163], v[188:191], v[8:11]
    v_mov_b32 v247, s98
    v_mfma_f32_16x16x32_bf16 v[12:15], v[132:135], v[148:151], v[12:15]
    v_mfma_f32_16x16x32_bf16 v[16:19], v[132:135], v[152:155], v[16:19]
    v_mfma_f32_16x16x32_bf16 v[20:23], v[132:135], v[156:159], v[20:23]
    v_mfma_f32_16x16x32_bf16 v[12:15], v[164:167], v[180:183], v[12:15]
    v_mfma_f32_16x16x32_bf16 v[16:19], v[164:167], v[184:187], v[16:19]
    v_mfma_f32_16x16x32_bf16 v[20:23], v[164:167], v[188:191], v[20:23]
    v_mfma_f32_16x16x32_bf16 v[24:27], v[136:139], v[148:151], v[24:27]
    v_cvt_pk_bf16_f32 v208, v0, v1
    v_cvt_pk_bf16_f32 v209, v2, v3
    v_mfma_f32_16x16x32_bf16 v[28:31], v[136:139], v[152:155], v[28:31]
    v_cvt_pk_bf16_f32 v210, v4, v5
    v_cvt_pk_bf16_f32 v212, v6, v7
    v_mfma_f32_16x16x32_bf16 v[32:35], v[136:139], v[156:159], v[32:35]
    v_cvt_pk_bf16_f32 v213, v8, v9
    v_cvt_pk_bf16_f32 v214, v10, v11
    v_mfma_f32_16x16x32_bf16 v[24:27], v[168:171], v[180:183], v[24:27]
    buffer_store_dwordx4 v[208:211], v200, s[28:31], s4 offen offset:0 sc1
    buffer_store_dwordx4 v[212:215], v200, s[28:31], s4 offen offset:256 sc1
    v_mfma_f32_16x16x32_bf16 v[28:31], v[168:171], v[184:187], v[28:31]
    ds_write_b128 v202, v[0:3] offset:0
    ds_write_b128 v202, v[4:7] offset:2304
    v_mfma_f32_16x16x32_bf16 v[32:35], v[168:171], v[188:191], v[32:35]
    ds_write_b128 v202, v[8:11] offset:4608
    v_mfma_f32_16x16x32_bf16 v[36:39], v[140:143], v[148:151], v[36:39]
    v_cvt_pk_bf16_f32 v216, v12, v13
    v_cvt_pk_bf16_f32 v217, v14, v15
    v_mfma_f32_16x16x32_bf16 v[40:43], v[140:143], v[152:155], v[40:43]
    v_cvt_pk_bf16_f32 v218, v16, v17
    v_cvt_pk_bf16_f32 v220, v18, v19
    v_mfma_f32_16x16x32_bf16 v[44:47], v[140:143], v[156:159], v[44:47]
    v_cvt_pk_bf16_f32 v221, v20, v21
    v_cvt_pk_bf16_f32 v222, v22, v23
    v_mfma_f32_16x16x32_bf16 v[36:39], v[172:175], v[180:183], v[36:39]
    buffer_store_dwordx4 v[216:219], v200, s[28:31], s4 offen offset:512 sc1
    buffer_store_dwordx4 v[220:223], v200, s[28:31], s4 offen offset:768 sc1
    v_mfma_f32_16x16x32_bf16 v[40:43], v[172:175], v[184:187], v[40:43]
    ds_write_b128 v202, v[12:15] offset:256
    ds_write_b128 v202, v[16:19] offset:2560
    v_mfma_f32_16x16x32_bf16 v[44:47], v[172:175], v[188:191], v[44:47]
    ds_write_b128 v202, v[20:23] offset:4864
    v_mfma_f32_16x16x32_bf16 v[48:51], v[144:147], v[148:151], v[48:51]
    v_cvt_pk_bf16_f32 v224, v24, v25
    v_cvt_pk_bf16_f32 v225, v26, v27
    v_mfma_f32_16x16x32_bf16 v[52:55], v[144:147], v[152:155], v[52:55]
    v_cvt_pk_bf16_f32 v226, v28, v29
    v_cvt_pk_bf16_f32 v228, v30, v31
    v_mfma_f32_16x16x32_bf16 v[56:59], v[144:147], v[156:159], v[56:59]
    v_cvt_pk_bf16_f32 v229, v32, v33
    v_cvt_pk_bf16_f32 v230, v34, v35
    v_mfma_f32_16x16x32_bf16 v[48:51], v[176:179], v[180:183], v[48:51]
    buffer_store_dwordx4 v[224:227], v200, s[28:31], s4 offen offset:1024 sc1
    buffer_store_dwordx4 v[228:231], v200, s[28:31], s4 offen offset:1280 sc1
    v_mfma_f32_16x16x32_bf16 v[52:55], v[176:179], v[184:187], v[52:55]
    ds_write_b128 v202, v[24:27] offset:512
    ds_write_b128 v202, v[28:31] offset:2816
    v_mfma_f32_16x16x32_bf16 v[56:59], v[176:179], v[188:191], v[56:59]
    ds_write_b128 v202, v[32:35] offset:5120
    v_cvt_pk_bf16_f32 v232, v36, v37
    v_cvt_pk_bf16_f32 v233, v38, v39
    v_cvt_pk_bf16_f32 v234, v40, v41
    v_cvt_pk_bf16_f32 v236, v42, v43
    v_cvt_pk_bf16_f32 v237, v44, v45
    v_cvt_pk_bf16_f32 v238, v46, v47
    buffer_store_dwordx4 v[232:235], v200, s[28:31], s4 offen offset:1536 sc1
    buffer_store_dwordx4 v[236:239], v200, s[28:31], s4 offen offset:1792 sc1
    ds_write_b128 v202, v[36:39] offset:768
    ds_write_b128 v202, v[40:43] offset:3072
    ds_write_b128 v202, v[44:47] offset:5376
    v_cvt_pk_bf16_f32 v240, v48, v49
    v_cvt_pk_bf16_f32 v241, v50, v51
    v_cvt_pk_bf16_f32 v242, v52, v53
    v_cvt_pk_bf16_f32 v244, v54, v55
    v_cvt_pk_bf16_f32 v245, v56, v57
    v_cvt_pk_bf16_f32 v246, v58, v59
    buffer_store_dwordx4 v[240:243], v200, s[28:31], s4 offen offset:2048 sc1
    buffer_store_dwordx4 v[244:247], v200, s[28:31], s4 offen offset:2304 sc1
    ds_write_b128 v202, v[48:51] offset:1024
    ds_write_b128 v202, v[52:55] offset:3328
    ds_write_b128 v202, v[56:59] offset:5632
OP_FIN:
    s_waitcnt lgkmcnt(0)
    s_barrier
    s_cmp_ge_u32 s42, 5
    s_cbranch_scc1 OP_DONE
    ds_read_b128 v[64:67], v249 offset:0
    ds_read_b128 v[68:71], v249 offset:2304
    ds_read_b128 v[72:75], v249 offset:4608
    s_mov_b32 s91, 0
OP_P2:
    buffer_load_dwordx4 v[168:171], v248, s[32:35], s56 offen offset:0 sc1
    buffer_load_dwordx4 v[172:175], v248, s[32:35], s56 offen offset:256 sc1
    buffer_load_dwordx4 v[176:179], v248, s[32:35], s57 offen offset:0 sc1
    buffer_load_dwordx4 v[180:183], v248, s[32:35], s57 offen offset:256 sc1
    buffer_load_dwordx4 v[184:187], v248, s[32:35], s58 offen offset:0 sc1
    buffer_load_dwordx4 v[188:191], v248, s[32:35], s58 offen offset:256 sc1
    s_add_u32 s91, s91, 1
    s_waitcnt vmcnt(0)
    v_xor_b32 v134, s98, v171
    v_xor_b32 v135, s98, v175
    v_or_b32 v134, v134, v135
    v_xor_b32 v135, s98, v179
    v_or_b32 v134, v134, v135
    v_xor_b32 v135, s98, v183
    v_or_b32 v134, v134, v135
    v_xor_b32 v135, s98, v187
    v_or_b32 v134, v134, v135
    v_xor_b32 v135, s98, v191
    v_or_b32 v134, v134, v135
    v_cmp_ne_u32 vcc, 0, v134
    s_cmp_lt_u32 s91, 0x40000
    s_cbranch_vccz OP_P2_GO
    s_sleep 1
    s_cbranch_scc1 OP_P2
OP_P2_GO:
    buffer_store_dword v199, v198, s[92:95], s96 offen sc1
    s_waitcnt lgkmcnt(0)
    v_lshlrev_b32 v134, 16, v168
    v_and_b32 v135, s59, v168
    v_add_f32 v64, v64, v134
    v_add_f32 v65, v65, v135
    v_lshlrev_b32 v134, 16, v176
    v_and_b32 v135, s59, v176
    v_add_f32 v64, v64, v134
    v_add_f32 v65, v65, v135
    v_lshlrev_b32 v134, 16, v184
    v_and_b32 v135, s59, v184
    v_add_f32 v64, v64, v134
    v_add_f32 v65, v65, v135
    v_cvt_pk_bf16_f32 v80, v64, v65
    v_lshlrev_b32 v134, 16, v169
    v_and_b32 v135, s59, v169
    v_add_f32 v66, v66, v134
    v_add_f32 v67, v67, v135
    v_lshlrev_b32 v134, 16, v177
    v_and_b32 v135, s59, v177
    v_add_f32 v66, v66, v134
    v_add_f32 v67, v67, v135
    v_lshlrev_b32 v134, 16, v185
    v_and_b32 v135, s59, v185
    v_add_f32 v66, v66, v134
    v_add_f32 v67, v67, v135
    v_cvt_pk_bf16_f32 v81, v66, v67
    buffer_store_dwordx2 v[80:81], v250, s[36:39], 0 offen
    v_lshlrev_b32 v134, 16, v170
    v_and_b32 v135, s59, v170
    v_add_f32 v68, v68, v134
    v_add_f32 v69, v69, v135
    v_lshlrev_b32 v134, 16, v178
    v_and_b32 v135, s59, v178
    v_add_f32 v68, v68, v134
    v_add_f32 v69, v69, v135
    v_lshlrev_b32 v134, 16, v186
    v_and_b32 v135, s59, v186
    v_add_f32 v68, v68, v134
    v_add_f32 v69, v69, v135
    v_cvt_pk_bf16_f32 v82, v68, v69
    v_lshlrev_b32 v134, 16, v172
    v_and_b32 v135, s59, v172
    v_add_f32 v70, v70, v134
    v_add_f32 v71, v71, v135
    v_lshlrev_b32 v134, 16, v180
    v_and_b32 v135, s59, v180
    v_add_f32 v70, v70, v134
    v_add_f32 v71, v71, v135
    v_lshlrev_b32 v134, 16, v188
    v_and_b32 v135, s59, v188
    v_add_f32 v70, v70, v134
    v_add_f32 v71, v71, v135
    v_cvt_pk_bf16_f32 v83, v70, v71
    buffer_store_dwordx2 v[82:83], v250, s[36:39], s10 offen
    v_lshlrev_b32 v134, 16, v173
    v_and_b32 v135, s59, v173
    v_add_f32 v72, v72, v134
    v_add_f32 v73, v73, v135
    v_lshlrev_b32 v134, 16, v181
    v_and_b32 v135, s59, v181
    v_add_f32 v72, v72, v134
    v_add_f32 v73, v73, v135
    v_lshlrev_b32 v134, 16, v189
    v_and_b32 v135, s59, v189
    v_add_f32 v72, v72, v134
    v_add_f32 v73, v73, v135
    v_cvt_pk_bf16_f32 v84, v72, v73
    v_lshlrev_b32 v134, 16, v174
    v_and_b32 v135, s59, v174
    v_add_f32 v74, v74, v134
    v_add_f32 v75, v75, v135
    v_lshlrev_b32 v134, 16, v182
    v_and_b32 v135, s59, v182
    v_add_f32 v74, v74, v134
    v_add_f32 v75, v75, v135
    v_lshlrev_b32 v134, 16, v190
    v_and_b32 v135, s59, v190
    v_add_f32 v74, v74, v134
    v_add_f32 v75, v75, v135
    v_cvt_pk_bf16_f32 v85, v74, v75
    buffer_store_dwordx2 v[84:85], v250, s[36:39], s11 offen
OP_DONE:
K1_END:
    s_endpgm
OP_LW:
    s_add_u32 s55, s48, 0
    s_and_b32 s55, s55, 3
    s_xor_b32 s61, s48, 0
    s_and_b32 s61, s61, 4
    s_or_b32 s55, s55, s61
    s_mul_i32 s55, s55, 147456
    s_mov_b32 m0, 36864
    s_add_u32 s56, s55, 0
    buffer_load_dwordx4 v224, s[20:23], s56 offen offset:0 lds
    buffer_load_dwordx4 v225, s[20:23], s56 offen offset:1024 lds
    buffer_load_dwordx4 v226, s[20:23], s56 offen offset:2048 lds
    buffer_load_dwordx4 v227, s[20:23], s56 offen offset:3072 lds
    s_mov_b32 m0, 40960
    s_add_u32 s56, s55, 9216
    buffer_load_dwordx4 v224, s[20:23], s56 offen offset:0 lds
    buffer_load_dwordx4 v225, s[20:23], s56 offen offset:1024 lds
    buffer_load_dwordx4 v226, s[20:23], s56 offen offset:2048 lds
    buffer_load_dwordx4 v227, s[20:23], s56 offen offset:3072 lds
    s_mov_b32 m0, 45056
    s_add_u32 s56, s55, 128
    buffer_load_dwordx4 v224, s[20:23], s56 offen offset:0 lds
    buffer_load_dwordx4 v225, s[20:23], s56 offen offset:1024 lds
    buffer_load_dwordx4 v226, s[20:23], s56 offen offset:2048 lds
    buffer_load_dwordx4 v227, s[20:23], s56 offen offset:3072 lds
    s_add_u32 s55, s48, 0
    s_and_b32 s55, s55, 3
    s_xor_b32 s61, s48, 0
    s_and_b32 s61, s61, 4
    s_or_b32 s55, s55, s61
    s_mul_i32 s55, s55, 147456
    s_add_u32 s55, s55, 73728
    s_mov_b32 m0, 57344
    s_add_u32 s56, s55, 0
    buffer_load_dwordx4 v224, s[20:23], s56 offen offset:0 lds
    buffer_load_dwordx4 v225, s[20:23], s56 offen offset:1024 lds
    buffer_load_dwordx4 v226, s[20:23], s56 offen offset:2048 lds
    buffer_load_dwordx4 v227, s[20:23], s56 offen offset:3072 lds
    s_mov_b32 m0, 61440
    s_add_u32 s56, s55, 9216
    buffer_load_dwordx4 v224, s[20:23], s56 offen offset:0 lds
    buffer_load_dwordx4 v225, s[20:23], s56 offen offset:1024 lds
    buffer_load_dwordx4 v226, s[20:23], s56 offen offset:2048 lds
    buffer_load_dwordx4 v227, s[20:23], s56 offen offset:3072 lds
    s_waitcnt vmcnt(0)
    s_barrier
    s_add_u32 s55, s48, 0
    s_and_b32 s55, s55, 3
    s_xor_b32 s61, s48, 4
    s_and_b32 s61, s61, 4
    s_or_b32 s55, s55, s61
    s_mul_i32 s55, s55, 147456
    s_mov_b32 m0, 77824
    s_add_u32 s56, s55, 0
    buffer_load_dwordx4 v224, s[20:23], s56 offen offset:0 lds
    buffer_load_dwordx4 v225, s[20:23], s56 offen offset:1024 lds
    buffer_load_dwordx4 v226, s[20:23], s56 offen offset:2048 lds
    buffer_load_dwordx4 v227, s[20:23], s56 offen offset:3072 lds
    s_mov_b32 m0, 81920
    s_add_u32 s56, s55, 9216
    buffer_load_dwordx4 v224, s[20:23], s56 offen offset:0 lds
    buffer_load_dwordx4 v225, s[20:23], s56 offen offset:1024 lds
    buffer_load_dwordx4 v226, s[20:23], s56 offen offset:2048 lds
    buffer_load_dwordx4 v227, s[20:23], s56 offen offset:3072 lds
    s_mov_b32 m0, 86016
    s_add_u32 s56, s55, 128
    buffer_load_dwordx4 v224, s[20:23], s56 offen offset:0 lds
    buffer_load_dwordx4 v225, s[20:23], s56 offen offset:1024 lds
    buffer_load_dwordx4 v226, s[20:23], s56 offen offset:2048 lds
    buffer_load_dwordx4 v227, s[20:23], s56 offen offset:3072 lds
    s_mov_b32 m0, 90112
    s_add_u32 s56, s55, 9344
    buffer_load_dwordx4 v224, s[20:23], s56 offen offset:0 lds
    buffer_load_dwordx4 v225, s[20:23], s56 offen offset:1024 lds
    buffer_load_dwordx4 v226, s[20:23], s56 offen offset:2048 lds
    buffer_load_dwordx4 v227, s[20:23], s56 offen offset:3072 lds
    s_add_u32 s55, s48, 0
    s_and_b32 s55, s55, 3
    s_xor_b32 s61, s48, 4
    s_and_b32 s61, s61, 4
    s_or_b32 s55, s55, s61
    s_mul_i32 s55, s55, 147456
    s_add_u32 s55, s55, 73728
    s_mov_b32 m0, 98304
    s_add_u32 s56, s55, 0
    buffer_load_dwordx4 v224, s[20:23], s56 offen offset:0 lds
    buffer_load_dwordx4 v225, s[20:23], s56 offen offset:1024 lds
    buffer_load_dwordx4 v226, s[20:23], s56 offen offset:2048 lds
    buffer_load_dwordx4 v227, s[20:23], s56 offen offset:3072 lds
    s_mov_b32 m0, 102400
    s_add_u32 s56, s55, 9216
    buffer_load_dwordx4 v224, s[20:23], s56 offen offset:0 lds
    buffer_load_dwordx4 v225, s[20:23], s56 offen offset:1024 lds
    buffer_load_dwordx4 v226, s[20:23], s56 offen offset:2048 lds
    buffer_load_dwordx4 v227, s[20:23], s56 offen offset:3072 lds
    s_mov_b32 m0, 106496
    s_add_u32 s56, s55, 128
    buffer_load_dwordx4 v224, s[20:23], s56 offen offset:0 lds
    buffer_load_dwordx4 v225, s[20:23], s56 offen offset:1024 lds
    buffer_load_dwordx4 v226, s[20:23], s56 offen offset:2048 lds
    buffer_load_dwordx4 v227, s[20:23], s56 offen offset:3072 lds
    s_mov_b32 m0, 110592
    s_add_u32 s56, s55, 9344
    buffer_load_dwordx4 v224, s[20:23], s56 offen offset:0 lds
    buffer_load_dwordx4 v225, s[20:23], s56 offen offset:1024 lds
    buffer_load_dwordx4 v226, s[20:23], s56 offen offset:2048 lds
    buffer_load_dwordx4 v227, s[20:23], s56 offen offset:3072 lds
    s_add_u32 s55, s48, 1
    s_and_b32 s55, s55, 3
    s_xor_b32 s61, s48, 0
    s_and_b32 s61, s61, 4
    s_or_b32 s55, s55, s61
    s_mul_i32 s55, s55, 147456
    s_mov_b32 m0, 118784
    s_add_u32 s56, s55, 0
    buffer_load_dwordx4 v224, s[20:23], s56 offen offset:0 lds
    buffer_load_dwordx4 v225, s[20:23], s56 offen offset:1024 lds
    buffer_load_dwordx4 v226, s[20:23], s56 offen offset:2048 lds
    buffer_load_dwordx4 v227, s[20:23], s56 offen offset:3072 lds
    s_mov_b32 m0, 122880
    s_add_u32 s56, s55, 9216
    buffer_load_dwordx4 v224, s[20:23], s56 offen offset:0 lds
    buffer_load_dwordx4 v225, s[20:23], s56 offen offset:1024 lds
    buffer_load_dwordx4 v226, s[20:23], s56 offen offset:2048 lds
    buffer_load_dwordx4 v227, s[20:23], s56 offen offset:3072 lds
    s_mov_b32 m0, 126976
    s_add_u32 s56, s55, 128
    buffer_load_dwordx4 v224, s[20:23], s56 offen offset:0 lds
    buffer_load_dwordx4 v225, s[20:23], s56 offen offset:1024 lds
    buffer_load_dwordx4 v226, s[20:23], s56 offen offset:2048 lds
    buffer_load_dwordx4 v227, s[20:23], s56 offen offset:3072 lds
    s_mov_b32 m0, 131072
    s_add_u32 s56, s55, 9344
    buffer_load_dwordx4 v224, s[20:23], s56 offen offset:0 lds
    buffer_load_dwordx4 v225, s[20:23], s56 offen offset:1024 lds
    buffer_load_dwordx4 v226, s[20:23], s56 offen offset:2048 lds
    buffer_load_dwordx4 v227, s[20:23], s56 offen offset:3072 lds
    s_add_u32 s55, s48, 1
    s_and_b32 s55, s55, 3
    s_xor_b32 s61, s48, 0
    s_and_b32 s61, s61, 4
    s_or_b32 s55, s55, s61
    s_mul_i32 s55, s55, 147456
    s_add_u32 s55, s55, 73728
    s_mov_b32 m0, 139264
    s_add_u32 s56, s55, 0
    buffer_load_dwordx4 v224, s[20:23], s56 offen offset:0 lds
    buffer_load_dwordx4 v225, s[20:23], s56 offen offset:1024 lds
    buffer_load_dwordx4 v226, s[20:23], s56 offen offset:2048 lds
    buffer_load_dwordx4 v227, s[20:23], s56 offen offset:3072 lds
    s_mov_b32 m0, 143360
    s_add_u32 s56, s55, 9216
    buffer_load_dwordx4 v224, s[20:23], s56 offen offset:0 lds
    buffer_load_dwordx4 v225, s[20:23], s56 offen offset:1024 lds
    buffer_load_dwordx4 v226, s[20:23], s56 offen offset:2048 lds
    buffer_load_dwordx4 v227, s[20:23], s56 offen offset:3072 lds
    s_mov_b32 m0, 147456
    s_add_u32 s56, s55, 128
    buffer_load_dwordx4 v224, s[20:23], s56 offen offset:0 lds
    buffer_load_dwordx4 v225, s[20:23], s56 offen offset:1024 lds
    buffer_load_dwordx4 v226, s[20:23], s56 offen offset:2048 lds
    buffer_load_dwordx4 v227, s[20:23], s56 offen offset:3072 lds
    s_waitcnt vmcnt(47)
    s_mov_b32 m0, 151552
    s_add_u32 s56, s55, 9344
    buffer_load_dwordx4 v224, s[20:23], s56 offen offset:0 lds
    buffer_load_dwordx4 v225, s[20:23], s56 offen offset:1024 lds
    buffer_load_dwordx4 v226, s[20:23], s56 offen offset:2048 lds
    buffer_load_dwordx4 v227, s[20:23], s56 offen offset:3072 lds
    s_waitcnt vmcnt(47)
    s_barrier
    s_add_u32 s55, s48, 1
    s_and_b32 s55, s55, 3
    s_xor_b32 s61, s48, 4
    s_and_b32 s61, s61, 4
    s_or_b32 s55, s55, s61
    s_mul_i32 s55, s55, 147456
    s_mov_b32 m0, 36864
    s_add_u32 s56, s55, 0
    buffer_load_dwordx4 v224, s[20:23], s56 offen offset:0 lds
    buffer_load_dwordx4 v225, s[20:23], s56 offen offset:1024 lds
    buffer_load_dwordx4 v226, s[20:23], s56 offen offset:2048 lds
    buffer_load_dwordx4 v227, s[20:23], s56 offen offset:3072 lds
    s_mov_b32 m0, 40960
    s_add_u32 s56, s55, 9216
    buffer_load_dwordx4 v224, s[20:23], s56 offen offset:0 lds
    buffer_load_dwordx4 v225, s[20:23], s56 offen offset:1024 lds
    buffer_load_dwordx4 v226, s[20:23], s56 offen offset:2048 lds
    buffer_load_dwordx4 v227, s[20:23], s56 offen offset:3072 lds
    s_mov_b32 m0, 45056
    s_add_u32 s56, s55, 128
    buffer_load_dwordx4 v224, s[20:23], s56 offen offset:0 lds
    buffer_load_dwordx4 v225, s[20:23], s56 offen offset:1024 lds
    buffer_load_dwordx4 v226, s[20:23], s56 offen offset:2048 lds
    buffer_load_dwordx4 v227, s[20:23], s56 offen offset:3072 lds
    s_mov_b32 m0, 49152
    s_add_u32 s56, s55, 9344
    buffer_load_dwordx4 v224, s[20:23], s56 offen offset:0 lds
    buffer_load_dwordx4 v225, s[20:23], s56 offen offset:1024 lds
    buffer_load_dwordx4 v226, s[20:23], s56 offen offset:2048 lds
    buffer_load_dwordx4 v227, s[20:23], s56 offen offset:3072 lds
    s_waitcnt vmcnt(47)
    s_barrier
    s_add_u32 s55, s48, 1
    s_and_b32 s55, s55, 3
    s_xor_b32 s61, s48, 4
    s_and_b32 s61, s61, 4
    s_or_b32 s55, s55, s61
    s_mul_i32 s55, s55, 147456
    s_add_u32 s55, s55, 73728
    s_mov_b32 m0, 57344
    s_add_u32 s56, s55, 0
    buffer_load_dwordx4 v224, s[20:23], s56 offen offset:0 lds
    buffer_load_dwordx4 v225, s[20:23], s56 offen offset:1024 lds
    buffer_load_dwordx4 v226, s[20:23], s56 offen offset:2048 lds
    buffer_load_dwordx4 v227, s[20:23], s56 offen offset:3072 lds
    s_mov_b32 m0, 61440
    s_add_u32 s56, s55, 9216
    buffer_load_dwordx4 v224, s[20:23], s56 offen offset:0 lds
    buffer_load_dwordx4 v225, s[20:23], s56 offen offset:1024 lds
    buffer_load_dwordx4 v226, s[20:23], s56 offen offset:2048 lds
    buffer_load_dwordx4 v227, s[20:23], s56 offen offset:3072 lds
    s_mov_b32 m0, 65536
    s_add_u32 s56, s55, 128
    buffer_load_dwordx4 v224, s[20:23], s56 offen offset:0 lds
    buffer_load_dwordx4 v225, s[20:23], s56 offen offset:1024 lds
    buffer_load_dwordx4 v226, s[20:23], s56 offen offset:2048 lds
    buffer_load_dwordx4 v227, s[20:23], s56 offen offset:3072 lds
    s_mov_b32 m0, 69632
    s_add_u32 s56, s55, 9344
    buffer_load_dwordx4 v224, s[20:23], s56 offen offset:0 lds
    buffer_load_dwordx4 v225, s[20:23], s56 offen offset:1024 lds
    buffer_load_dwordx4 v226, s[20:23], s56 offen offset:2048 lds
    buffer_load_dwordx4 v227, s[20:23], s56 offen offset:3072 lds
    s_waitcnt vmcnt(47)
    s_barrier
    s_add_u32 s55, s48, 1
    s_and_b32 s55, s55, 3
    s_xor_b32 s61, s48, 4
    s_and_b32 s61, s61, 4
    s_or_b32 s55, s55, s61
    s_mul_i32 s55, s55, 147456
    s_add_u32 s55, s55, 73728
    s_mov_b32 m0, 73728
    s_add_u32 s56, s55, 0
    buffer_load_dwordx4 v232, s[20:23], s56 offen offset:0 lds
    buffer_load_dwordx4 v233, s[20:23], s56 offen offset:1024 lds
    buffer_load_dwordx4 v234, s[20:23], s56 offen offset:2048 lds
    buffer_load_dwordx4 v235, s[20:23], s56 offen offset:3072 lds
    s_add_u32 s55, s48, 2
    s_and_b32 s55, s55, 3
    s_xor_b32 s61, s48, 0
    s_and_b32 s61, s61, 4
    s_or_b32 s55, s55, s61
    s_mul_i32 s55, s55, 147456
    s_mov_b32 m0, 77824
    s_add_u32 s56, s55, 0
    buffer_load_dwordx4 v224, s[20:23], s56 offen offset:0 lds
    buffer_load_dwordx4 v225, s[20:23], s56 offen offset:1024 lds
    buffer_load_dwordx4 v226, s[20:23], s56 offen offset:2048 lds
    buffer_load_dwordx4 v227, s[20:23], s56 offen offset:3072 lds
    s_mov_b32 m0, 81920
    s_add_u32 s56, s55, 9216
    buffer_load_dwordx4 v224, s[20:23], s56 offen offset:0 lds
    buffer_load_dwordx4 v225, s[20:23], s56 offen offset:1024 lds
    buffer_load_dwordx4 v226, s[20:23], s56 offen offset:2048 lds
    buffer_load_dwordx4 v227, s[20:23], s56 offen offset:3072 lds
    s_waitcnt vmcnt(44)
    s_barrier
    s_add_u32 s55, s48, 2
    s_and_b32 s55, s55, 3
    s_xor_b32 s61, s48, 0
    s_and_b32 s61, s61, 4
    s_or_b32 s55, s55, s61
    s_mul_i32 s55, s55, 147456
    s_mov_b32 m0, 90112
    s_add_u32 s56, s55, 9344
    buffer_load_dwordx4 v224, s[20:23], s56 offen offset:0 lds
    buffer_load_dwordx4 v225, s[20:23], s56 offen offset:1024 lds
    buffer_load_dwordx4 v226, s[20:23], s56 offen offset:2048 lds
    buffer_load_dwordx4 v227, s[20:23], s56 offen offset:3072 lds
    s_mov_b32 m0, 94208
    s_add_u32 s56, s55, 0
    buffer_load_dwordx4 v232, s[20:23], s56 offen offset:0 lds
    buffer_load_dwordx4 v233, s[20:23], s56 offen offset:1024 lds
    buffer_load_dwordx4 v234, s[20:23], s56 offen offset:2048 lds
    buffer_load_dwordx4 v235, s[20:23], s56 offen offset:3072 lds
    s_add_u32 s55, s48, 2
    s_and_b32 s55, s55, 3
    s_xor_b32 s61, s48, 0
    s_and_b32 s61, s61, 4
    s_or_b32 s55, s55, s61
    s_mul_i32 s55, s55, 147456
    s_add_u32 s55, s55, 73728
    s_mov_b32 m0, 98304
    s_add_u32 s56, s55, 0
    buffer_load_dwordx4 v224, s[20:23], s56 offen offset:0 lds
    buffer_load_dwordx4 v225, s[20:23], s56 offen offset:1024 lds
    buffer_load_dwordx4 v226, s[20:23], s56 offen offset:2048 lds
    buffer_load_dwordx4 v227, s[20:23], s56 offen offset:3072 lds
    s_mov_b32 m0, 102400
    s_add_u32 s56, s55, 9216
    buffer_load_dwordx4 v224, s[20:23], s56 offen offset:0 lds
    buffer_load_dwordx4 v225, s[20:23], s56 offen offset:1024 lds
    buffer_load_dwordx4 v226, s[20:23], s56 offen offset:2048 lds
    buffer_load_dwordx4 v227, s[20:23], s56 offen offset:3072 lds
    s_waitcnt vmcnt(44)
    s_barrier
    s_add_u32 s55, s48, 2
    s_and_b32 s55, s55, 3
    s_xor_b32 s61, s48, 0
    s_and_b32 s61, s61, 4
    s_or_b32 s55, s55, s61
    s_mul_i32 s55, s55, 147456
    s_add_u32 s55, s55, 73728
    s_mov_b32 m0, 106496
    s_add_u32 s56, s55, 128
    buffer_load_dwordx4 v224, s[20:23], s56 offen offset:0 lds
    buffer_load_dwordx4 v225, s[20:23], s56 offen offset:1024 lds
    buffer_load_dwordx4 v226, s[20:23], s56 offen offset:2048 lds
    buffer_load_dwordx4 v227, s[20:23], s56 offen offset:3072 lds
    s_mov_b32 m0, 110592
    s_add_u32 s56, s55, 9344
    buffer_load_dwordx4 v224, s[20:23], s56 offen offset:0 lds
    buffer_load_dwordx4 v225, s[20:23], s56 offen offset:1024 lds
    buffer_load_dwordx4 v226, s[20:23], s56 offen offset:2048 lds
    buffer_load_dwordx4 v227, s[20:23], s56 offen offset:3072 lds
    s_mov_b32 m0, 114688
    s_add_u32 s56, s55, 0
    buffer_load_dwordx4 v232, s[20:23], s56 offen offset:0 lds
    buffer_load_dwordx4 v233, s[20:23], s56 offen offset:1024 lds
    buffer_load_dwordx4 v234, s[20:23], s56 offen offset:2048 lds
    buffer_load_dwordx4 v235, s[20:23], s56 offen offset:3072 lds
    s_waitcnt vmcnt(36)
    s_barrier
    s_add_u32 s55, s48, 2
    s_and_b32 s55, s55, 3
    s_xor_b32 s61, s48, 4
    s_and_b32 s61, s61, 4
    s_or_b32 s55, s55, s61
    s_mul_i32 s55, s55, 147456
    s_mov_b32 m0, 126976
    s_add_u32 s56, s55, 128
    buffer_load_dwordx4 v224, s[20:23], s56 offen offset:0 lds
    buffer_load_dwordx4 v225, s[20:23], s56 offen offset:1024 lds
    buffer_load_dwordx4 v226, s[20:23], s56 offen offset:2048 lds
    buffer_load_dwordx4 v227, s[20:23], s56 offen offset:3072 lds
    s_mov_b32 m0, 131072
    s_add_u32 s56, s55, 9344
    buffer_load_dwordx4 v224, s[20:23], s56 offen offset:0 lds
    buffer_load_dwordx4 v225, s[20:23], s56 offen offset:1024 lds
    buffer_load_dwordx4 v226, s[20:23], s56 offen offset:2048 lds
    buffer_load_dwordx4 v227, s[20:23], s56 offen offset:3072 lds
    s_mov_b32 m0, 135168
    s_add_u32 s56, s55, 0
    buffer_load_dwordx4 v232, s[20:23], s56 offen offset:0 lds
    buffer_load_dwordx4 v233, s[20:23], s56 offen offset:1024 lds
    buffer_load_dwordx4 v234, s[20:23], s56 offen offset:2048 lds
    buffer_load_dwordx4 v235, s[20:23], s56 offen offset:3072 lds
    s_add_u32 s55, s48, 2
    s_and_b32 s55, s55, 3
    s_xor_b32 s61, s48, 4
    s_and_b32 s61, s61, 4
    s_or_b32 s55, s55, s61
    s_mul_i32 s55, s55, 147456
    s_add_u32 s55, s55, 73728
    s_mov_b32 m0, 139264
    s_add_u32 s56, s55, 0
    buffer_load_dwordx4 v224, s[20:23], s56 offen offset:0 lds
    buffer_load_dwordx4 v225, s[20:23], s56 offen offset:1024 lds
    buffer_load_dwordx4 v226, s[20:23], s56 offen offset:2048 lds
    buffer_load_dwordx4 v227, s[20:23], s56 offen offset:3072 lds
    s_waitcnt vmcnt(36)
    s_barrier
    s_add_u32 s55, s48, 2
    s_and_b32 s55, s55, 3
    s_xor_b32 s61, s48, 4
    s_and_b32 s61, s61, 4
    s_or_b32 s55, s55, s61
    s_mul_i32 s55, s55, 147456
    s_add_u32 s55, s55, 73728
    s_mov_b32 m0, 143360
    s_add_u32 s56, s55, 9216
    buffer_load_dwordx4 v224, s[20:23], s56 offen offset:0 lds
    buffer_load_dwordx4 v225, s[20:23], s56 offen offset:1024 lds
    buffer_load_dwordx4 v226, s[20:23], s56 offen offset:2048 lds
    buffer_load_dwordx4 v227, s[20:23], s56 offen offset:3072 lds
    s_mov_b32 m0, 147456
    s_add_u32 s56, s55, 128
    buffer_load_dwordx4 v224, s[20:23], s56 offen offset:0 lds
    buffer_load_dwordx4 v225, s[20:23], s56 offen offset:1024 lds
    buffer_load_dwordx4 v226, s[20:23], s56 offen offset:2048 lds
    buffer_load_dwordx4 v227, s[20:23], s56 offen offset:3072 lds
    s_mov_b32 m0, 151552
    s_add_u32 s56, s55, 9344
    buffer_load_dwordx4 v224, s[20:23], s56 offen offset:0 lds
    buffer_load_dwordx4 v225, s[20:23], s56 offen offset:1024 lds
    buffer_load_dwordx4 v226, s[20:23], s56 offen offset:2048 lds
    buffer_load_dwordx4 v227, s[20:23], s56 offen offset:3072 lds
    s_waitcnt vmcnt(28)
    s_barrier
    s_add_u32 s55, s48, 3
    s_and_b32 s55, s55, 3
    s_xor_b32 s61, s48, 0
    s_and_b32 s61, s61, 4
    s_or_b32 s55, s55, s61
    s_mul_i32 s55, s55, 147456
    s_mov_b32 m0, 36864
    s_add_u32 s56, s55, 0
    buffer_load_dwordx4 v224, s[20:23], s56 offen offset:0 lds
    buffer_load_dwordx4 v225, s[20:23], s56 offen offset:1024 lds
    buffer_load_dwordx4 v226, s[20:23], s56 offen offset:2048 lds
    buffer_load_dwordx4 v227, s[20:23], s56 offen offset:3072 lds
    s_mov_b32 m0, 40960
    s_add_u32 s56, s55, 9216
    buffer_load_dwordx4 v224, s[20:23], s56 offen offset:0 lds
    buffer_load_dwordx4 v225, s[20:23], s56 offen offset:1024 lds
    buffer_load_dwordx4 v226, s[20:23], s56 offen offset:2048 lds
    buffer_load_dwordx4 v227, s[20:23], s56 offen offset:3072 lds
    s_mov_b32 m0, 45056
    s_add_u32 s56, s55, 128
    buffer_load_dwordx4 v224, s[20:23], s56 offen offset:0 lds
    buffer_load_dwordx4 v225, s[20:23], s56 offen offset:1024 lds
    buffer_load_dwordx4 v226, s[20:23], s56 offen offset:2048 lds
    buffer_load_dwordx4 v227, s[20:23], s56 offen offset:3072 lds
    s_mov_b32 m0, 49152
    s_add_u32 s56, s55, 9344
    buffer_load_dwordx4 v224, s[20:23], s56 offen offset:0 lds
    buffer_load_dwordx4 v225, s[20:23], s56 offen offset:1024 lds
    buffer_load_dwordx4 v226, s[20:23], s56 offen offset:2048 lds
    buffer_load_dwordx4 v227, s[20:23], s56 offen offset:3072 lds
    s_waitcnt vmcnt(32)
    s_barrier
    s_add_u32 s55, s48, 3
    s_and_b32 s55, s55, 3
    s_xor_b32 s61, s48, 0
    s_and_b32 s61, s61, 4
    s_or_b32 s55, s55, s61
    s_mul_i32 s55, s55, 147456
    s_mov_b32 m0, 53248
    s_add_u32 s56, s55, 0
    buffer_load_dwordx4 v232, s[20:23], s56 offen offset:0 lds
    buffer_load_dwordx4 v233, s[20:23], s56 offen offset:1024 lds
    buffer_load_dwordx4 v234, s[20:23], s56 offen offset:2048 lds
    buffer_load_dwordx4 v235, s[20:23], s56 offen offset:3072 lds
    s_add_u32 s55, s48, 3
    s_and_b32 s55, s55, 3
    s_xor_b32 s61, s48, 0
    s_and_b32 s61, s61, 4
    s_or_b32 s55, s55, s61
    s_mul_i32 s55, s55, 147456
    s_add_u32 s55, s55, 73728
    s_mov_b32 m0, 57344
    s_add_u32 s56, s55, 0
    buffer_load_dwordx4 v224, s[20:23], s56 offen offset:0 lds
    buffer_load_dwordx4 v225, s[20:23], s56 offen offset:1024 lds
    buffer_load_dwordx4 v226, s[20:23], s56 offen offset:2048 lds
    buffer_load_dwordx4 v227, s[20:23], s56 offen offset:3072 lds
    s_mov_b32 m0, 61440
    s_add_u32 s56, s55, 9216
    buffer_load_dwordx4 v224, s[20:23], s56 offen offset:0 lds
    buffer_load_dwordx4 v225, s[20:23], s56 offen offset:1024 lds
    buffer_load_dwordx4 v226, s[20:23], s56 offen offset:2048 lds
    buffer_load_dwordx4 v227, s[20:23], s56 offen offset:3072 lds
    s_waitcnt vmcnt(28)
    s_barrier
    s_add_u32 s55, s48, 3
    s_and_b32 s55, s55, 3
    s_xor_b32 s61, s48, 0
    s_and_b32 s61, s61, 4
    s_or_b32 s55, s55, s61
    s_mul_i32 s55, s55, 147456
    s_add_u32 s55, s55, 73728
    s_mov_b32 m0, 69632
    s_add_u32 s56, s55, 9344
    buffer_load_dwordx4 v224, s[20:23], s56 offen offset:0 lds
    buffer_load_dwordx4 v225, s[20:23], s56 offen offset:1024 lds
    buffer_load_dwordx4 v226, s[20:23], s56 offen offset:2048 lds
    buffer_load_dwordx4 v227, s[20:23], s56 offen offset:3072 lds
    s_mov_b32 m0, 73728
    s_add_u32 s56, s55, 0
    buffer_load_dwordx4 v232, s[20:23], s56 offen offset:0 lds
    buffer_load_dwordx4 v233, s[20:23], s56 offen offset:1024 lds
    buffer_load_dwordx4 v234, s[20:23], s56 offen offset:2048 lds
    buffer_load_dwordx4 v235, s[20:23], s56 offen offset:3072 lds
    s_add_u32 s55, s48, 3
    s_and_b32 s55, s55, 3
    s_xor_b32 s61, s48, 4
    s_and_b32 s61, s61, 4
    s_or_b32 s55, s55, s61
    s_mul_i32 s55, s55, 147456
    s_mov_b32 m0, 77824
    s_add_u32 s56, s55, 0
    buffer_load_dwordx4 v224, s[20:23], s56 offen offset:0 lds
    buffer_load_dwordx4 v225, s[20:23], s56 offen offset:1024 lds
    buffer_load_dwordx4 v226, s[20:23], s56 offen offset:2048 lds
    buffer_load_dwordx4 v227, s[20:23], s56 offen offset:3072 lds
    s_mov_b32 m0, 81920
    s_add_u32 s56, s55, 9216
    buffer_load_dwordx4 v224, s[20:23], s56 offen offset:0 lds
    buffer_load_dwordx4 v225, s[20:23], s56 offen offset:1024 lds
    buffer_load_dwordx4 v226, s[20:23], s56 offen offset:2048 lds
    buffer_load_dwordx4 v227, s[20:23], s56 offen offset:3072 lds
    s_waitcnt vmcnt(24)
    s_barrier
    s_add_u32 s55, s48, 3
    s_and_b32 s55, s55, 3
    s_xor_b32 s61, s48, 4
    s_and_b32 s61, s61, 4
    s_or_b32 s55, s55, s61
    s_mul_i32 s55, s55, 147456
    s_mov_b32 m0, 86016
    s_add_u32 s56, s55, 128
    buffer_load_dwordx4 v224, s[20:23], s56 offen offset:0 lds
    buffer_load_dwordx4 v225, s[20:23], s56 offen offset:1024 lds
    buffer_load_dwordx4 v226, s[20:23], s56 offen offset:2048 lds
    buffer_load_dwordx4 v227, s[20:23], s56 offen offset:3072 lds
    s_mov_b32 m0, 90112
    s_add_u32 s56, s55, 9344
    buffer_load_dwordx4 v224, s[20:23], s56 offen offset:0 lds
    buffer_load_dwordx4 v225, s[20:23], s56 offen offset:1024 lds
    buffer_load_dwordx4 v226, s[20:23], s56 offen offset:2048 lds
    buffer_load_dwordx4 v227, s[20:23], s56 offen offset:3072 lds
    s_mov_b32 m0, 94208
    s_add_u32 s56, s55, 0
    buffer_load_dwordx4 v232, s[20:23], s56 offen offset:0 lds
    buffer_load_dwordx4 v233, s[20:23], s56 offen offset:1024 lds
    buffer_load_dwordx4 v234, s[20:23], s56 offen offset:2048 lds
    buffer_load_dwordx4 v235, s[20:23], s56 offen offset:3072 lds
    s_waitcnt vmcnt(20)
    s_barrier
    s_add_u32 s55, s48, 3
    s_and_b32 s55, s55, 3
    s_xor_b32 s61, s48, 4
    s_and_b32 s61, s61, 4
    s_or_b32 s55, s55, s61
    s_mul_i32 s55, s55, 147456
    s_add_u32 s55, s55, 73728
    s_mov_b32 m0, 102400
    s_add_u32 s56, s55, 9216
    buffer_load_dwordx4 v224, s[20:23], s56 offen offset:0 lds
    buffer_load_dwordx4 v225, s[20:23], s56 offen offset:1024 lds
    buffer_load_dwordx4 v226, s[20:23], s56 offen offset:2048 lds
    buffer_load_dwordx4 v227, s[20:23], s56 offen offset:3072 lds
    s_mov_b32 m0, 106496
    s_add_u32 s56, s55, 128
    buffer_load_dwordx4 v224, s[20:23], s56 offen offset:0 lds
    buffer_load_dwordx4 v225, s[20:23], s56 offen offset:1024 lds
    buffer_load_dwordx4 v226, s[20:23], s56 offen offset:2048 lds
    buffer_load_dwordx4 v227, s[20:23], s56 offen offset:3072 lds
    s_mov_b32 m0, 110592
    s_add_u32 s56, s55, 9344
    buffer_load_dwordx4 v224, s[20:23], s56 offen offset:0 lds
    buffer_load_dwordx4 v225, s[20:23], s56 offen offset:1024 lds
    buffer_load_dwordx4 v226, s[20:23], s56 offen offset:2048 lds
    buffer_load_dwordx4 v227, s[20:23], s56 offen offset:3072 lds
    s_mov_b32 m0, 114688
    s_add_u32 s56, s55, 0
    buffer_load_dwordx4 v232, s[20:23], s56 offen offset:0 lds
    buffer_load_dwordx4 v233, s[20:23], s56 offen offset:1024 lds
    buffer_load_dwordx4 v234, s[20:23], s56 offen offset:2048 lds
    buffer_load_dwordx4 v235, s[20:23], s56 offen offset:3072 lds
    s_waitcnt vmcnt(16)
    s_barrier
    s_waitcnt vmcnt(0)
    s_barrier
    s_barrier
    s_barrier
    s_branch OP_DONE
OP_LO:
    s_mov_b32 s3, 0xff
    s_add_u32 s55, s48, 0
    s_and_b32 s55, s55, 3
    s_xor_b32 s61, s48, 0
    s_and_b32 s61, s61, 4
    s_or_b32 s55, s55, s61
    s_mul_i32 s55, s55, 147456
    s_mov_b32 m0, 49152
    s_add_u32 s56, s55, 9344
    buffer_load_dwordx4 v224, s[20:23], s56 offen offset:0 lds
    buffer_load_dwordx4 v225, s[20:23], s56 offen offset:1024 lds
    buffer_load_dwordx4 v226, s[20:23], s56 offen offset:2048 lds
    buffer_load_dwordx4 v227, s[20:23], s56 offen offset:3072 lds
    s_mov_b32 m0, 53248
    s_add_u32 s56, s55, 0
    buffer_load_dwordx4 v232, s[20:23], s56 offen offset:0 lds
    buffer_load_dwordx4 v233, s[20:23], s56 offen offset:1024 lds
    buffer_load_dwordx4 v234, s[20:23], s56 offen offset:2048 lds
    buffer_load_dwordx4 v235, s[20:23], s56 offen offset:3072 lds
    s_add_u32 s55, s48, 0
    s_and_b32 s55, s55, 3
    s_xor_b32 s61, s48, 0
    s_and_b32 s61, s61, 4
    s_or_b32 s55, s55, s61
    s_mul_i32 s55, s55, 147456
    s_add_u32 s55, s55, 73728
    s_mov_b32 m0, 65536
    s_add_u32 s56, s55, 128
    buffer_load_dwordx4 v224, s[20:23], s56 offen offset:0 lds
    buffer_load_dwordx4 v225, s[20:23], s56 offen offset:1024 lds
    buffer_load_dwordx4 v226, s[20:23], s56 offen offset:2048 lds
    buffer_load_dwordx4 v227, s[20:23], s56 offen offset:3072 lds
    s_mov_b32 m0, 69632
    s_add_u32 s56, s55, 9344
    buffer_load_dwordx4 v224, s[20:23], s56 offen offset:0 lds
    buffer_load_dwordx4 v225, s[20:23], s56 offen offset:1024 lds
    buffer_load_dwordx4 v226, s[20:23], s56 offen offset:2048 lds
    buffer_load_dwordx4 v227, s[20:23], s56 offen offset:3072 lds
    s_mov_b32 m0, 73728
    s_add_u32 s56, s55, 0
    buffer_load_dwordx4 v232, s[20:23], s56 offen offset:0 lds
    buffer_load_dwordx4 v233, s[20:23], s56 offen offset:1024 lds
    buffer_load_dwordx4 v234, s[20:23], s56 offen offset:2048 lds
    buffer_load_dwordx4 v235, s[20:23], s56 offen offset:3072 lds
    s_waitcnt vmcnt(0)
    s_barrier
    s_add_u32 s55, s48, 0
    s_and_b32 s55, s55, 3
    s_xor_b32 s61, s48, 4
    s_and_b32 s61, s61, 4
    s_or_b32 s55, s55, s61
    s_mul_i32 s55, s55, 147456
    s_mov_b32 m0, 94208
    s_add_u32 s56, s55, 0
    buffer_load_dwordx4 v232, s[20:23], s56 offen offset:0 lds
    buffer_load_dwordx4 v233, s[20:23], s56 offen offset:1024 lds
    buffer_load_dwordx4 v234, s[20:23], s56 offen offset:2048 lds
    buffer_load_dwordx4 v235, s[20:23], s56 offen offset:3072 lds
    s_add_u32 s55, s48, 0
    s_and_b32 s55, s55, 3
    s_xor_b32 s61, s48, 4
    s_and_b32 s61, s61, 4
    s_or_b32 s55, s55, s61
    s_mul_i32 s55, s55, 147456
    s_add_u32 s55, s55, 73728
    s_mov_b32 m0, 114688
    s_add_u32 s56, s55, 0
    buffer_load_dwordx4 v232, s[20:23], s56 offen offset:0 lds
    buffer_load_dwordx4 v233, s[20:23], s56 offen offset:1024 lds
    buffer_load_dwordx4 v234, s[20:23], s56 offen offset:2048 lds
    buffer_load_dwordx4 v235, s[20:23], s56 offen offset:3072 lds
    s_add_u32 s55, s48, 0
    s_and_b32 s55, s55, 3
    s_xor_b32 s61, s48, 4
    s_and_b32 s61, s61, 4
    s_or_b32 s55, s55, s61
    s_bitcmp1_b32 s3, s55
    s_cbranch_scc0 HP11_GO
    s_mov_b32 s91, 0
HP11:
    buffer_load_dword v230, v229, s[92:95], s99 offen sc1
    s_add_u32 s91, s91, 1
    s_waitcnt vmcnt(0)
    v_cmp_ne_u32 vcc, s97, v230
    s_nop 0
    s_mov_b32 s3, vcc_lo
    s_bitcmp1_b32 s3, s55
    s_cbranch_scc0 HP11_GO
    s_sleep 1
    s_cmp_lt_u32 s91, 0x40000
    s_cbranch_scc1 HP11
HP11_GO:
    s_lshl_b32 s55, s55, 12
    s_mov_b32 m0, 24576
    s_add_u32 s56, s55, 0
    buffer_load_dwordx4 v254, s[24:27], s56 offen offset:0 lds
    buffer_load_dwordx4 v254, s[24:27], s56 offen offset:1024 lds
    buffer_load_dwordx4 v228, s[24:27], s56 offen offset:2048 lds
    buffer_load_dwordx4 v228, s[24:27], s56 offen offset:3072 lds
    s_mov_b32 m0, 28672
    s_add_u32 s56, s55, 262144
    buffer_load_dwordx4 v254, s[24:27], s56 offen offset:0 lds
    buffer_load_dwordx4 v254, s[24:27], s56 offen offset:1024 lds
    buffer_load_dwordx4 v228, s[24:27], s56 offen offset:2048 lds
    buffer_load_dwordx4 v228, s[24:27], s56 offen offset:3072 lds
    s_mov_b32 m0, 32768
    s_add_u32 s56, s55, 524288
    buffer_load_dwordx4 v254, s[24:27], s56 offen offset:0 lds
    buffer_load_dwordx4 v254, s[24:27], s56 offen offset:1024 lds
    buffer_load_dwordx4 v228, s[24:27], s56 offen offset:2048 lds
    buffer_load_dwordx4 v228, s[24:27], s56 offen offset:3072 lds
    s_add_u32 s55, s48, 1
    s_and_b32 s55, s55, 3
    s_xor_b32 s61, s48, 0
    s_and_b32 s61, s61, 4
    s_or_b32 s55, s55, s61
    s_mul_i32 s55, s55, 147456
    s_mov_b32 m0, 135168
    s_add_u32 s56, s55, 0
    buffer_load_dwordx4 v232, s[20:23], s56 offen offset:0 lds
    buffer_load_dwordx4 v233, s[20:23], s56 offen offset:1024 lds
    buffer_load_dwordx4 v234, s[20:23], s56 offen offset:2048 lds
    buffer_load_dwordx4 v235, s[20:23], s56 offen offset:3072 lds
    s_add_u32 s55, s48, 1
    s_and_b32 s55, s55, 3
    s_xor_b32 s61, s48, 0
    s_and_b32 s61, s61, 4
    s_or_b32 s55, s55, s61
    s_mul_i32 s55, s55, 147456
    s_add_u32 s55, s55, 73728
    s_mov_b32 m0, 155648
    s_add_u32 s56, s55, 0
    buffer_load_dwordx4 v232, s[20:23], s56 offen offset:0 lds
    buffer_load_dwordx4 v233, s[20:23], s56 offen offset:1024 lds
    buffer_load_dwordx4 v234, s[20:23], s56 offen offset:2048 lds
    buffer_load_dwordx4 v235, s[20:23], s56 offen offset:3072 lds
    s_waitcnt vmcnt(8)
    s_barrier
    s_add_u32 s55, s48, 0
    s_and_b32 s55, s55, 3
    s_xor_b32 s61, s48, 4
    s_and_b32 s61, s61, 4
    s_or_b32 s55, s55, s61
    s_lshl_b32 s55, s55, 12
    s_add_u32 s55, s55, 2048
    s_mov_b32 m0, 0
    s_add_u32 s56, s55, 0
    buffer_load_dwordx4 v254, s[24:27], s56 offen offset:0 lds
    buffer_load_dwordx4 v254, s[24:27], s56 offen offset:1024 lds
    buffer_load_dwordx4 v228, s[24:27], s56 offen offset:2048 lds
    buffer_load_dwordx4 v228, s[24:27], s56 offen offset:3072 lds
    s_mov_b32 m0, 4096
    s_add_u32 s56, s55, 262144
    buffer_load_dwordx4 v254, s[24:27], s56 offen offset:0 lds
    buffer_load_dwordx4 v254, s[24:27], s56 offen offset:1024 lds
    buffer_load_dwordx4 v228, s[24:27], s56 offen offset:2048 lds
    buffer_load_dwordx4 v228, s[24:27], s56 offen offset:3072 lds
    s_mov_b32 m0, 8192
    s_add_u32 s56, s55, 524288
    buffer_load_dwordx4 v254, s[24:27], s56 offen offset:0 lds
    buffer_load_dwordx4 v254, s[24:27], s56 offen offset:1024 lds
    buffer_load_dwordx4 v228, s[24:27], s56 offen offset:2048 lds
    buffer_load_dwordx4 v228, s[24:27], s56 offen offset:3072 lds
    s_add_u32 s55, s48, 1
    s_and_b32 s55, s55, 3
    s_xor_b32 s61, s48, 0
    s_and_b32 s61, s61, 4
    s_or_b32 s55, s55, s61
    s_bitcmp1_b32 s3, s55
    s_cbranch_scc0 HP12_GO
    s_mov_b32 s91, 0
HP12:
    buffer_load_dword v230, v229, s[92:95], s99 offen sc1
    s_add_u32 s91, s91, 1
    s_waitcnt vmcnt(0)
    v_cmp_ne_u32 vcc, s97, v230
    s_nop 0
    s_mov_b32 s3, vcc_lo
    s_bitcmp1_b32 s3, s55
    s_cbranch_scc0 HP12_GO
    s_sleep 1
    s_cmp_lt_u32 s91, 0x40000
    s_cbranch_scc1 HP12
HP12_GO:
    s_lshl_b32 s55, s55, 12
    s_mov_b32 m0, 12288
    s_add_u32 s56, s55, 0
    buffer_load_dwordx4 v254, s[24:27], s56 offen offset:0 lds
    buffer_load_dwordx4 v254, s[24:27], s56 offen offset:1024 lds
    buffer_load_dwordx4 v228, s[24:27], s56 offen offset:2048 lds
    buffer_load_dwordx4 v228, s[24:27], s56 offen offset:3072 lds
    s_mov_b32 m0, 16384
    s_add_u32 s56, s55, 262144
    buffer_load_dwordx4 v254, s[24:27], s56 offen offset:0 lds
    buffer_load_dwordx4 v254, s[24:27], s56 offen offset:1024 lds
    buffer_load_dwordx4 v228, s[24:27], s56 offen offset:2048 lds
    buffer_load_dwordx4 v228, s[24:27], s56 offen offset:3072 lds
    s_mov_b32 m0, 20480
    s_add_u32 s56, s55, 524288
    buffer_load_dwordx4 v254, s[24:27], s56 offen offset:0 lds
    buffer_load_dwordx4 v254, s[24:27], s56 offen offset:1024 lds
    buffer_load_dwordx4 v228, s[24:27], s56 offen offset:2048 lds
    buffer_load_dwordx4 v228, s[24:27], s56 offen offset:3072 lds
    s_add_u32 s55, s48, 1
    s_and_b32 s55, s55, 3
    s_xor_b32 s61, s48, 4
    s_and_b32 s61, s61, 4
    s_or_b32 s55, s55, s61
    s_mul_i32 s55, s55, 147456
    s_mov_b32 m0, 53248
    s_add_u32 s56, s55, 0
    buffer_load_dwordx4 v232, s[20:23], s56 offen offset:0 lds
    buffer_load_dwordx4 v233, s[20:23], s56 offen offset:1024 lds
    buffer_load_dwordx4 v234, s[20:23], s56 offen offset:2048 lds
    buffer_load_dwordx4 v235, s[20:23], s56 offen offset:3072 lds
    s_waitcnt vmcnt(16)
    s_barrier
    s_add_u32 s55, s48, 1
    s_and_b32 s55, s55, 3
    s_xor_b32 s61, s48, 0
    s_and_b32 s61, s61, 4
    s_or_b32 s55, s55, s61
    s_lshl_b32 s55, s55, 12
    s_add_u32 s55, s55, 2048
    s_mov_b32 m0, 24576
    s_add_u32 s56, s55, 0
    buffer_load_dwordx4 v254, s[24:27], s56 offen offset:0 lds
    buffer_load_dwordx4 v254, s[24:27], s56 offen offset:1024 lds
    buffer_load_dwordx4 v228, s[24:27], s56 offen offset:2048 lds
    buffer_load_dwordx4 v228, s[24:27], s56 offen offset:3072 lds
    s_mov_b32 m0, 28672
    s_add_u32 s56, s55, 262144
    buffer_load_dwordx4 v254, s[24:27], s56 offen offset:0 lds
    buffer_load_dwordx4 v254, s[24:27], s56 offen offset:1024 lds
    buffer_load_dwordx4 v228, s[24:27], s56 offen offset:2048 lds
    buffer_load_dwordx4 v228, s[24:27], s56 offen offset:3072 lds
    s_mov_b32 m0, 32768
    s_add_u32 s56, s55, 524288
    buffer_load_dwordx4 v254, s[24:27], s56 offen offset:0 lds
    buffer_load_dwordx4 v254, s[24:27], s56 offen offset:1024 lds
    buffer_load_dwordx4 v228, s[24:27], s56 offen offset:2048 lds
    buffer_load_dwordx4 v228, s[24:27], s56 offen offset:3072 lds
    s_waitcnt vmcnt(16)
    s_barrier
    s_add_u32 s55, s48, 1
    s_and_b32 s55, s55, 3
    s_xor_b32 s61, s48, 4
    s_and_b32 s61, s61, 4
    s_or_b32 s55, s55, s61
    s_bitcmp1_b32 s3, s55
    s_cbranch_scc0 HP13_GO
    s_mov_b32 s91, 0
HP13:
    buffer_load_dword v230, v229, s[92:95], s99 offen sc1
    s_add_u32 s91, s91, 1
    s_waitcnt vmcnt(0)
    v_cmp_ne_u32 vcc, s97, v230
    s_nop 0
    s_mov_b32 s3, vcc_lo
    s_bitcmp1_b32 s3, s55
    s_cbranch_scc0 HP13_GO
    s_sleep 1
    s_cmp_lt_u32 s91, 0x40000
    s_cbranch_scc1 HP13
HP13_GO:
    s_lshl_b32 s55, s55, 12
    s_mov_b32 m0, 0
    s_add_u32 s56, s55, 0
    buffer_load_dwordx4 v254, s[24:27], s56 offen offset:0 lds
    buffer_load_dwordx4 v254, s[24:27], s56 offen offset:1024 lds
    buffer_load_dwordx4 v228, s[24:27], s56 offen offset:2048 lds
    buffer_load_dwordx4 v228, s[24:27], s56 offen offset:3072 lds
    s_mov_b32 m0, 4096
    s_add_u32 s56, s55, 262144
    buffer_load_dwordx4 v254, s[24:27], s56 offen offset:0 lds
    buffer_load_dwordx4 v254, s[24:27], s56 offen offset:1024 lds
    buffer_load_dwordx4 v228, s[24:27], s56 offen offset:2048 lds
    buffer_load_dwordx4 v228, s[24:27], s56 offen offset:3072 lds
    s_mov_b32 m0, 8192
    s_add_u32 s56, s55, 524288
    buffer_load_dwordx4 v254, s[24:27], s56 offen offset:0 lds
    buffer_load_dwordx4 v254, s[24:27], s56 offen offset:1024 lds
    buffer_load_dwordx4 v228, s[24:27], s56 offen offset:2048 lds
    buffer_load_dwordx4 v228, s[24:27], s56 offen offset:3072 lds
    s_add_u32 s55, s48, 2
    s_and_b32 s55, s55, 3
    s_xor_b32 s61, s48, 0
    s_and_b32 s61, s61, 4
    s_or_b32 s55, s55, s61
    s_mul_i32 s55, s55, 147456
    s_mov_b32 m0, 86016
    s_add_u32 s56, s55, 128
    buffer_load_dwordx4 v224, s[20:23], s56 offen offset:0 lds
    buffer_load_dwordx4 v225, s[20:23], s56 offen offset:1024 lds
    buffer_load_dwordx4 v226, s[20:23], s56 offen offset:2048 lds
    buffer_load_dwordx4 v227, s[20:23], s56 offen offset:3072 lds
    s_waitcnt vmcnt(16)
    s_barrier
    s_add_u32 s55, s48, 1
    s_and_b32 s55, s55, 3
    s_xor_b32 s61, s48, 4
    s_and_b32 s61, s61, 4
    s_or_b32 s55, s55, s61
    s_lshl_b32 s55, s55, 12
    s_add_u32 s55, s55, 2048
    s_mov_b32 m0, 12288
    s_add_u32 s56, s55, 0
    buffer_load_dwordx4 v254, s[24:27], s56 offen offset:0 lds
    buffer_load_dwordx4 v254, s[24:27], s56 offen offset:1024 lds
    buffer_load_dwordx4 v228, s[24:27], s56 offen offset:2048 lds
    buffer_load_dwordx4 v228, s[24:27], s56 offen offset:3072 lds
    s_mov_b32 m0, 16384
    s_add_u32 s56, s55, 262144
    buffer_load_dwordx4 v254, s[24:27], s56 offen offset:0 lds
    buffer_load_dwordx4 v254, s[24:27], s56 offen offset:1024 lds
    buffer_load_dwordx4 v228, s[24:27], s56 offen offset:2048 lds
    buffer_load_dwordx4 v228, s[24:27], s56 offen offset:3072 lds
    s_mov_b32 m0, 20480
    s_add_u32 s56, s55, 524288
    buffer_load_dwordx4 v254, s[24:27], s56 offen offset:0 lds
    buffer_load_dwordx4 v254, s[24:27], s56 offen offset:1024 lds
    buffer_load_dwordx4 v228, s[24:27], s56 offen offset:2048 lds
    buffer_load_dwordx4 v228, s[24:27], s56 offen offset:3072 lds
    s_waitcnt vmcnt(16)
    s_barrier
    s_add_u32 s55, s48, 2
    s_and_b32 s55, s55, 3
    s_xor_b32 s61, s48, 0
    s_and_b32 s61, s61, 4
    s_or_b32 s55, s55, s61
    s_bitcmp1_b32 s3, s55
    s_cbranch_scc0 HP14_GO
    s_mov_b32 s91, 0
HP14:
    buffer_load_dword v230, v229, s[92:95], s99 offen sc1
    s_add_u32 s91, s91, 1
    s_waitcnt vmcnt(0)
    v_cmp_ne_u32 vcc, s97, v230
    s_nop 0
    s_mov_b32 s3, vcc_lo
    s_bitcmp1_b32 s3, s55
    s_cbranch_scc0 HP14_GO
    s_sleep 1
    s_cmp_lt_u32 s91, 0x40000
    s_cbranch_scc1 HP14
HP14_GO:
    s_lshl_b32 s55, s55, 12
    s_mov_b32 m0, 24576
    s_add_u32 s56, s55, 0
    buffer_load_dwordx4 v254, s[24:27], s56 offen offset:0 lds
    buffer_load_dwordx4 v254, s[24:27], s56 offen offset:1024 lds
    buffer_load_dwordx4 v228, s[24:27], s56 offen offset:2048 lds
    buffer_load_dwordx4 v228, s[24:27], s56 offen offset:3072 lds
    s_mov_b32 m0, 28672
    s_add_u32 s56, s55, 262144
    buffer_load_dwordx4 v254, s[24:27], s56 offen offset:0 lds
    buffer_load_dwordx4 v254, s[24:27], s56 offen offset:1024 lds
    buffer_load_dwordx4 v228, s[24:27], s56 offen offset:2048 lds
    buffer_load_dwordx4 v228, s[24:27], s56 offen offset:3072 lds
    s_mov_b32 m0, 32768
    s_add_u32 s56, s55, 524288
    buffer_load_dwordx4 v254, s[24:27], s56 offen offset:0 lds
    buffer_load_dwordx4 v254, s[24:27], s56 offen offset:1024 lds
    buffer_load_dwordx4 v228, s[24:27], s56 offen offset:2048 lds
    buffer_load_dwordx4 v228, s[24:27], s56 offen offset:3072 lds
    s_add_u32 s55, s48, 2
    s_and_b32 s55, s55, 3
    s_xor_b32 s61, s48, 4
    s_and_b32 s61, s61, 4
    s_or_b32 s55, s55, s61
    s_mul_i32 s55, s55, 147456
    s_mov_b32 m0, 118784
    s_add_u32 s56, s55, 0
    buffer_load_dwordx4 v224, s[20:23], s56 offen offset:0 lds
    buffer_load_dwordx4 v225, s[20:23], s56 offen offset:1024 lds
    buffer_load_dwordx4 v226, s[20:23], s56 offen offset:2048 lds
    buffer_load_dwordx4 v227, s[20:23], s56 offen offset:3072 lds
    s_mov_b32 m0, 122880
    s_add_u32 s56, s55, 9216
    buffer_load_dwordx4 v224, s[20:23], s56 offen offset:0 lds
    buffer_load_dwordx4 v225, s[20:23], s56 offen offset:1024 lds
    buffer_load_dwordx4 v226, s[20:23], s56 offen offset:2048 lds
    buffer_load_dwordx4 v227, s[20:23], s56 offen offset:3072 lds
    s_waitcnt vmcnt(20)
    s_barrier
    s_add_u32 s55, s48, 2
    s_and_b32 s55, s55, 3
    s_xor_b32 s61, s48, 0
    s_and_b32 s61, s61, 4
    s_or_b32 s55, s55, s61
    s_lshl_b32 s55, s55, 12
    s_add_u32 s55, s55, 2048
    s_mov_b32 m0, 0
    s_add_u32 s56, s55, 0
    buffer_load_dwordx4 v254, s[24:27], s56 offen offset:0 lds
    buffer_load_dwordx4 v254, s[24:27], s56 offen offset:1024 lds
    buffer_load_dwordx4 v228, s[24:27], s56 offen offset:2048 lds
    buffer_load_dwordx4 v228, s[24:27], s56 offen offset:3072 lds
    s_mov_b32 m0, 4096
    s_add_u32 s56, s55, 262144
    buffer_load_dwordx4 v254, s[24:27], s56 offen offset:0 lds
    buffer_load_dwordx4 v254, s[24:27], s56 offen offset:1024 lds
    buffer_load_dwordx4 v228, s[24:27], s56 offen offset:2048 lds
    buffer_load_dwordx4 v228, s[24:27], s56 offen offset:3072 lds
    s_mov_b32 m0, 8192
    s_add_u32 s56, s55, 524288
    buffer_load_dwordx4 v254, s[24:27], s56 offen offset:0 lds
    buffer_load_dwordx4 v254, s[24:27], s56 offen offset:1024 lds
    buffer_load_dwordx4 v228, s[24:27], s56 offen offset:2048 lds
    buffer_load_dwordx4 v228, s[24:27], s56 offen offset:3072 lds
    s_waitcnt vmcnt(20)
    s_barrier
    s_add_u32 s55, s48, 2
    s_and_b32 s55, s55, 3
    s_xor_b32 s61, s48, 4
    s_and_b32 s61, s61, 4
    s_or_b32 s55, s55, s61
    s_bitcmp1_b32 s3, s55
    s_cbranch_scc0 HP15_GO
    s_mov_b32 s91, 0
HP15:
    buffer_load_dword v230, v229, s[92:95], s99 offen sc1
    s_add_u32 s91, s91, 1
    s_waitcnt vmcnt(0)
    v_cmp_ne_u32 vcc, s97, v230
    s_nop 0
    s_mov_b32 s3, vcc_lo
    s_bitcmp1_b32 s3, s55
    s_cbranch_scc0 HP15_GO
    s_sleep 1
    s_cmp_lt_u32 s91, 0x40000
    s_cbranch_scc1 HP15
HP15_GO:
    s_lshl_b32 s55, s55, 12
    s_mov_b32 m0, 12288
    s_add_u32 s56, s55, 0
    buffer_load_dwordx4 v254, s[24:27], s56 offen offset:0 lds
    buffer_load_dwordx4 v254, s[24:27], s56 offen offset:1024 lds
    buffer_load_dwordx4 v228, s[24:27], s56 offen offset:2048 lds
    buffer_load_dwordx4 v228, s[24:27], s56 offen offset:3072 lds
    s_mov_b32 m0, 16384
    s_add_u32 s56, s55, 262144
    buffer_load_dwordx4 v254, s[24:27], s56 offen offset:0 lds
    buffer_load_dwordx4 v254, s[24:27], s56 offen offset:1024 lds
    buffer_load_dwordx4 v228, s[24:27], s56 offen offset:2048 lds
    buffer_load_dwordx4 v228, s[24:27], s56 offen offset:3072 lds
    s_mov_b32 m0, 20480
    s_add_u32 s56, s55, 524288
    buffer_load_dwordx4 v254, s[24:27], s56 offen offset:0 lds
    buffer_load_dwordx4 v254, s[24:27], s56 offen offset:1024 lds
    buffer_load_dwordx4 v228, s[24:27], s56 offen offset:2048 lds
    buffer_load_dwordx4 v228, s[24:27], s56 offen offset:3072 lds
    s_add_u32 s55, s48, 2
    s_and_b32 s55, s55, 3
    s_xor_b32 s61, s48, 4
    s_and_b32 s61, s61, 4
    s_or_b32 s55, s55, s61
    s_mul_i32 s55, s55, 147456
    s_add_u32 s55, s55, 73728
    s_mov_b32 m0, 155648
    s_add_u32 s56, s55, 0
    buffer_load_dwordx4 v232, s[20:23], s56 offen offset:0 lds
    buffer_load_dwordx4 v233, s[20:23], s56 offen offset:1024 lds
    buffer_load_dwordx4 v234, s[20:23], s56 offen offset:2048 lds
    buffer_load_dwordx4 v235, s[20:23], s56 offen offset:3072 lds
    s_waitcnt vmcnt(16)
    s_barrier
    s_add_u32 s55, s48, 2
    s_and_b32 s55, s55, 3
    s_xor_b32 s61, s48, 4
    s_and_b32 s61, s61, 4
    s_or_b32 s55, s55, s61
    s_lshl_b32 s55, s55, 12
    s_add_u32 s55, s55, 2048
    s_mov_b32 m0, 24576
    s_add_u32 s56, s55, 0
    buffer_load_dwordx4 v254, s[24:27], s56 offen offset:0 lds
    buffer_load_dwordx4 v254, s[24:27], s56 offen offset:1024 lds
    buffer_load_dwordx4 v228, s[24:27], s56 offen offset:2048 lds
    buffer_load_dwordx4 v228, s[24:27], s56 offen offset:3072 lds
    s_mov_b32 m0, 28672
    s_add_u32 s56, s55, 262144
    buffer_load_dwordx4 v254, s[24:27], s56 offen offset:0 lds
    buffer_load_dwordx4 v254, s[24:27], s56 offen offset:1024 lds
    buffer_load_dwordx4 v228, s[24:27], s56 offen offset:2048 lds
    buffer_load_dwordx4 v228, s[24:27], s56 offen offset:3072 lds
    s_mov_b32 m0, 32768
    s_add_u32 s56, s55, 524288
    buffer_load_dwordx4 v254, s[24:27], s56 offen offset:0 lds
    buffer_load_dwordx4 v254, s[24:27], s56 offen offset:1024 lds
    buffer_load_dwordx4 v228, s[24:27], s56 offen offset:2048 lds
    buffer_load_dwordx4 v228, s[24:27], s56 offen offset:3072 lds
    s_waitcnt vmcnt(16)
    s_barrier
    s_add_u32 s55, s48, 3
    s_and_b32 s55, s55, 3
    s_xor_b32 s61, s48, 0
    s_and_b32 s61, s61, 4
    s_or_b32 s55, s55, s61
    s_bitcmp1_b32 s3, s55
    s_cbranch_scc0 HP16_GO
    s_mov_b32 s91, 0
HP16:
    buffer_load_dword v230, v229, s[92:95], s99 offen sc1
    s_add_u32 s91, s91, 1
    s_waitcnt vmcnt(0)
    v_cmp_ne_u32 vcc, s97, v230
    s_nop 0
    s_mov_b32 s3, vcc_lo
    s_bitcmp1_b32 s3, s55
    s_cbranch_scc0 HP16_GO
    s_sleep 1
    s_cmp_lt_u32 s91, 0x40000
    s_cbranch_scc1 HP16
HP16_GO:
    s_lshl_b32 s55, s55, 12
    s_mov_b32 m0, 0
    s_add_u32 s56, s55, 0
    buffer_load_dwordx4 v254, s[24:27], s56 offen offset:0 lds
    buffer_load_dwordx4 v254, s[24:27], s56 offen offset:1024 lds
    buffer_load_dwordx4 v228, s[24:27], s56 offen offset:2048 lds
    buffer_load_dwordx4 v228, s[24:27], s56 offen offset:3072 lds
    s_mov_b32 m0, 4096
    s_add_u32 s56, s55, 262144
    buffer_load_dwordx4 v254, s[24:27], s56 offen offset:0 lds
    buffer_load_dwordx4 v254, s[24:27], s56 offen offset:1024 lds
    buffer_load_dwordx4 v228, s[24:27], s56 offen offset:2048 lds
    buffer_load_dwordx4 v228, s[24:27], s56 offen offset:3072 lds
    s_mov_b32 m0, 8192
    s_add_u32 s56, s55, 524288
    buffer_load_dwordx4 v254, s[24:27], s56 offen offset:0 lds
    buffer_load_dwordx4 v254, s[24:27], s56 offen offset:1024 lds
    buffer_load_dwordx4 v228, s[24:27], s56 offen offset:2048 lds
    buffer_load_dwordx4 v228, s[24:27], s56 offen offset:3072 lds
    s_add_u32 s55, s48, 3
    s_and_b32 s55, s55, 3
    s_xor_b32 s61, s48, 0
    s_and_b32 s61, s61, 4
    s_or_b32 s55, s55, s61
    s_mul_i32 s55, s55, 147456
    s_add_u32 s55, s55, 73728
    s_mov_b32 m0, 65536
    s_add_u32 s56, s55, 128
    buffer_load_dwordx4 v224, s[20:23], s56 offen offset:0 lds
    buffer_load_dwordx4 v225, s[20:23], s56 offen offset:1024 lds
    buffer_load_dwordx4 v226, s[20:23], s56 offen offset:2048 lds
    buffer_load_dwordx4 v227, s[20:23], s56 offen offset:3072 lds
    s_waitcnt vmcnt(16)
    s_barrier
    s_add_u32 s55, s48, 3
    s_and_b32 s55, s55, 3
    s_xor_b32 s61, s48, 0
    s_and_b32 s61, s61, 4
    s_or_b32 s55, s55, s61
    s_lshl_b32 s55, s55, 12
    s_add_u32 s55, s55, 2048
    s_mov_b32 m0, 12288
    s_add_u32 s56, s55, 0
    buffer_load_dwordx4 v254, s[24:27], s56 offen offset:0 lds
    buffer_load_dwordx4 v254, s[24:27], s56 offen offset:1024 lds
    buffer_load_dwordx4 v228, s[24:27], s56 offen offset:2048 lds
    buffer_load_dwordx4 v228, s[24:27], s56 offen offset:3072 lds
    s_mov_b32 m0, 16384
    s_add_u32 s56, s55, 262144
    buffer_load_dwordx4 v254, s[24:27], s56 offen offset:0 lds
    buffer_load_dwordx4 v254, s[24:27], s56 offen offset:1024 lds
    buffer_load_dwordx4 v228, s[24:27], s56 offen offset:2048 lds
    buffer_load_dwordx4 v228, s[24:27], s56 offen offset:3072 lds
    s_mov_b32 m0, 20480
    s_add_u32 s56, s55, 524288
    buffer_load_dwordx4 v254, s[24:27], s56 offen offset:0 lds
    buffer_load_dwordx4 v254, s[24:27], s56 offen offset:1024 lds
    buffer_load_dwordx4 v228, s[24:27], s56 offen offset:2048 lds
    buffer_load_dwordx4 v228, s[24:27], s56 offen offset:3072 lds
    s_waitcnt vmcnt(16)
    s_barrier
    s_add_u32 s55, s48, 3
    s_and_b32 s55, s55, 3
    s_xor_b32 s61, s48, 4
    s_and_b32 s61, s61, 4
    s_or_b32 s55, s55, s61
    s_bitcmp1_b32 s3, s55
    s_cbranch_scc0 HP17_GO
    s_mov_b32 s91, 0
HP17:
    buffer_load_dword v230, v229, s[92:95], s99 offen sc1
    s_add_u32 s91, s91, 1
    s_waitcnt vmcnt(0)
    v_cmp_ne_u32 vcc, s97, v230
    s_nop 0
    s_mov_b32 s3, vcc_lo
    s_bitcmp1_b32 s3, s55
    s_cbranch_scc0 HP17_GO
    s_sleep 1
    s_cmp_lt_u32 s91, 0x40000
    s_cbranch_scc1 HP17
HP17_GO:
    s_lshl_b32 s55, s55, 12
    s_mov_b32 m0, 24576
    s_add_u32 s56, s55, 0
    buffer_load_dwordx4 v254, s[24:27], s56 offen offset:0 lds
    buffer_load_dwordx4 v254, s[24:27], s56 offen offset:1024 lds
    buffer_load_dwordx4 v228, s[24:27], s56 offen offset:2048 lds
    buffer_load_dwordx4 v228, s[24:27], s56 offen offset:3072 lds
    s_mov_b32 m0, 28672
    s_add_u32 s56, s55, 262144
    buffer_load_dwordx4 v254, s[24:27], s56 offen offset:0 lds
    buffer_load_dwordx4 v254, s[24:27], s56 offen offset:1024 lds
    buffer_load_dwordx4 v228, s[24:27], s56 offen offset:2048 lds
    buffer_load_dwordx4 v228, s[24:27], s56 offen offset:3072 lds
    s_mov_b32 m0, 32768
    s_add_u32 s56, s55, 524288
    buffer_load_dwordx4 v254, s[24:27], s56 offen offset:0 lds
    buffer_load_dwordx4 v254, s[24:27], s56 offen offset:1024 lds
    buffer_load_dwordx4 v228, s[24:27], s56 offen offset:2048 lds
    buffer_load_dwordx4 v228, s[24:27], s56 offen offset:3072 lds
    s_add_u32 s55, s48, 3
    s_and_b32 s55, s55, 3
    s_xor_b32 s61, s48, 4
    s_and_b32 s61, s61, 4
    s_or_b32 s55, s55, s61
    s_mul_i32 s55, s55, 147456
    s_add_u32 s55, s55, 73728
    s_mov_b32 m0, 98304
    s_add_u32 s56, s55, 0
    buffer_load_dwordx4 v224, s[20:23], s56 offen offset:0 lds
    buffer_load_dwordx4 v225, s[20:23], s56 offen offset:1024 lds
    buffer_load_dwordx4 v226, s[20:23], s56 offen offset:2048 lds
    buffer_load_dwordx4 v227, s[20:23], s56 offen offset:3072 lds
    s_waitcnt vmcnt(16)
    s_barrier
    s_add_u32 s55, s48, 3
    s_and_b32 s55, s55, 3
    s_xor_b32 s61, s48, 4
    s_and_b32 s61, s61, 4
    s_or_b32 s55, s55, s61
    s_lshl_b32 s55, s55, 12
    s_add_u32 s55, s55, 2048
    s_mov_b32 m0, 0
    s_add_u32 s56, s55, 0
    buffer_load_dwordx4 v254, s[24:27], s56 offen offset:0 lds
    buffer_load_dwordx4 v254, s[24:27], s56 offen offset:1024 lds
    buffer_load_dwordx4 v228, s[24:27], s56 offen offset:2048 lds
    buffer_load_dwordx4 v228, s[24:27], s56 offen offset:3072 lds
    s_mov_b32 m0, 4096
    s_add_u32 s56, s55, 262144
    buffer_load_dwordx4 v254, s[24:27], s56 offen offset:0 lds
    buffer_load_dwordx4 v254, s[24:27], s56 offen offset:1024 lds
    buffer_load_dwordx4 v228, s[24:27], s56 offen offset:2048 lds
    buffer_load_dwordx4 v228, s[24:27], s56 offen offset:3072 lds
    s_mov_b32 m0, 8192
    s_add_u32 s56, s55, 524288
    buffer_load_dwordx4 v254, s[24:27], s56 offen offset:0 lds
    buffer_load_dwordx4 v254, s[24:27], s56 offen offset:1024 lds
    buffer_load_dwordx4 v228, s[24:27], s56 offen offset:2048 lds
    buffer_load_dwordx4 v228, s[24:27], s56 offen offset:3072 lds
    s_waitcnt vmcnt(16)
    s_barrier
    s_waitcnt vmcnt(0)
    s_barrier
    s_barrier
    s_barrier
    s_branch OP_DONE
P2_RARE:
    s_cmp_ge_u32 s45, 65536
    s_cselect_b32 s47, 0, 163840
    s_sub_u32 s47, s47, 65536
    v_add_u32 v243, s47, v248
    ds_read_b128 v[192:195], v243 offset:0
    ds_read_b128 v[196:199], v243 offset:512
    ds_read_b128 v[200:203], v243 offset:1024
    ds_read_b128 v[204:207], v243 offset:1536
    s_waitcnt lgkmcnt(0)
    v_mfma_f32_16x16x32_bf16 v[168:171], v[192:195], v[96:99], v[224:227]
    v_mfma_f32_16x16x32_bf16 v[172:175], v[192:195], v[100:103], v[228:231]
    v_mfma_f32_16x16x32_bf16 v[176:179], v[192:195], v[104:107], v[232:235]
    v_mfma_f32_16x16x32_bf16 v[168:171], v[196:199], v[108:111], v[168:171]
    v_mfma_f32_16x16x32_bf16 v[172:175], v[196:199], v[112:115], v[172:175]
    v_mfma_f32_16x16x32_bf16 v[176:179], v[196:199], v[116:119], v[176:179]
    v_mfma_f32_16x16x32_bf16 v[168:171], v[200:203], v[120:123], v[168:171]
    v_mfma_f32_16x16x32_bf16 v[172:175], v[200:203], v[124:127], v[172:175]
    v_mfma_f32_16x16x32_bf16 v[176:179], v[200:203], v[128:131], v[176:179]
    v_mfma_f32_16x16x32_bf16 v[168:171], v[204:207], v[132:135], v[168:171]
    v_mfma_f32_16x16x32_bf16 v[172:175], v[204:207], v[136:139], v[172:175]
    v_mfma_f32_16x16x32_bf16 v[176:179], v[204:207], v[140:143], v[176:179]
    ds_read_b128 v[192:195], v243 offset:4096
    ds_read_b128 v[196:199], v243 offset:4608
    ds_read_b128 v[200:203], v243 offset:5120
    ds_read_b128 v[204:207], v243 offset:5632
    s_waitcnt lgkmcnt(0)
    v_mfma_f32_16x16x32_bf16 v[180:183], v[192:195], v[96:99], v[224:227]
    v_mfma_f32_16x16x32_bf16 v[184:187], v[192:195], v[100:103], v[228:231]
    v_mfma_f32_16x16x32_bf16 v[188:191], v[192:195], v[104:107], v[232:235]
    v_mfma_f32_16x16x32_bf16 v[180:183], v[196:199], v[108:111], v[180:183]
    v_mfma_f32_16x16x32_bf16 v[184:187], v[196:199], v[112:115], v[184:187]
    v_mfma_f32_16x16x32_bf16 v[188:191], v[196:199], v[116:119], v[188:191]
    v_mfma_f32_16x16x32_bf16 v[180:183], v[200:203], v[120:123], v[180:183]
    v_mfma_f32_16x16x32_bf16 v[184:187], v[200:203], v[124:127], v[184:187]
    v_mfma_f32_16x16x32_bf16 v[188:191], v[200:203], v[128:131], v[188:191]
    v_mfma_f32_16x16x32_bf16 v[180:183], v[204:207], v[132:135], v[180:183]
    v_mfma_f32_16x16x32_bf16 v[184:187], v[204:207], v[136:139], v[184:187]
    v_mfma_f32_16x16x32_bf16 v[188:191], v[204:207], v[140:143], v[188:191]
    s_nop 7
    v_max3_f32 v237, v168, v169, v170
    v_max3_f32 v238, v172, v173, v174
    v_max3_f32 v239, v176, v177, v178
    v_max3_f32 v237, v237, v171, v180
    v_max3_f32 v238, v238, v175, v184
    v_max3_f32 v239, v239, v179, v188
    v_max3_f32 v237, v237, v181, v182
    v_max3_f32 v238, v238, v185, v186
    v_max3_f32 v239, v239, v189, v190
    v_max_f32 v237, v237, v183
    v_max_f32 v238, v238, v187
    v_max_f32 v239, v239, v191
    v_mov_b32 v240, v237
    v_mov_b32 v241, v238
    v_mov_b32 v242, v239
    v_permlane32_swap_b32 v237, v240
    v_permlane32_swap_b32 v238, v241
    v_permlane32_swap_b32 v239, v242
    v_max_f32 v237, v237, v240
    v_max_f32 v238, v238, v241
    v_max_f32 v239, v239, v242
    v_mov_b32 v240, v237
    v_mov_b32 v241, v238
    v_mov_b32 v242, v239
    v_permlane16_swap_b32 v237, v240
    v_permlane16_swap_b32 v238, v241
    v_permlane16_swap_b32 v239, v242
    v_max_f32 v237, v237, v240
    v_max_f32 v238, v238, v241
    v_max_f32 v239, v239, v242
    v_max_f32 v237, 0, v237
    v_max_f32 v238, 0, v238
    v_max_f32 v239, 0, v239
    v_exp_f32 v240, -v237
    v_exp_f32 v241, -v238
    v_exp_f32 v242, -v239
    v_sub_f32 v168, v168, v237
    v_sub_f32 v169, v169, v237
    v_sub_f32 v170, v170, v237
    v_sub_f32 v171, v171, v237
    v_sub_f32 v180, v180, v237
    v_sub_f32 v181, v181, v237
    v_sub_f32 v182, v182, v237
    v_sub_f32 v183, v183, v237
    v_sub_f32 v144, v144, v237
    v_sub_f32 v145, v145, v237
    v_sub_f32 v146, v146, v237
    v_sub_f32 v147, v147, v237
    v_sub_f32 v156, v156, v237
    v_sub_f32 v157, v157, v237
    v_sub_f32 v158, v158, v237
    v_sub_f32 v159, v159, v237
    v_sub_f32 v224, v224, v237
    v_sub_f32 v225, v225, v237
    v_sub_f32 v226, v226, v237
    v_sub_f32 v227, v227, v237
    v_mul_f32 v251, v251, v240
    v_mul_f32 v0, v0, v240
    v_mul_f32 v1, v1, v240
    v_mul_f32 v2, v2, v240
    v_mul_f32 v3, v3, v240
    v_mul_f32 v12, v12, v240
    v_mul_f32 v13, v13, v240
    v_mul_f32 v14, v14, v240
    v_mul_f32 v15, v15, v240
    v_mul_f32 v24, v24, v240
    v_mul_f32 v25, v25, v240
    v_mul_f32 v26, v26, v240
    v_mul_f32 v27, v27, v240
    v_mul_f32 v36, v36, v240
    v_mul_f32 v37, v37, v240
    v_mul_f32 v38, v38, v240
    v_mul_f32 v39, v39, v240
    v_mul_f32 v48, v48, v240
    v_mul_f32 v49, v49, v240
    v_mul_f32 v50, v50, v240
    v_mul_f32 v51, v51, v240
    v_mul_f32 v60, v60, v240
    v_mul_f32 v61, v61, v240
    v_mul_f32 v62, v62, v240
    v_mul_f32 v63, v63, v240
    v_mul_f32 v72, v72, v240
    v_mul_f32 v73, v73, v240
    v_mul_f32 v74, v74, v240
    v_mul_f32 v75, v75, v240
    v_mul_f32 v84, v84, v240
    v_mul_f32 v85, v85, v240
    v_mul_f32 v86, v86, v240
    v_mul_f32 v87, v87, v240
    v_sub_f32 v172, v172, v238
    v_sub_f32 v173, v173, v238
    v_sub_f32 v174, v174, v238
    v_sub_f32 v175, v175, v238
    v_sub_f32 v184, v184, v238
    v_sub_f32 v185, v185, v238
    v_sub_f32 v186, v186, v238
    v_sub_f32 v187, v187, v238
    v_sub_f32 v148, v148, v238
    v_sub_f32 v149, v149, v238
    v_sub_f32 v150, v150, v238
    v_sub_f32 v151, v151, v238
    v_sub_f32 v160, v160, v238
    v_sub_f32 v161, v161, v238
    v_sub_f32 v162, v162, v238
    v_sub_f32 v163, v163, v238
    v_sub_f32 v228, v228, v238
    v_sub_f32 v229, v229, v238
    v_sub_f32 v230, v230, v238
    v_sub_f32 v231, v231, v238
    v_mul_f32 v252, v252, v241
    v_mul_f32 v4, v4, v241
    v_mul_f32 v5, v5, v241
    v_mul_f32 v6, v6, v241
    v_mul_f32 v7, v7, v241
    v_mul_f32 v16, v16, v241
    v_mul_f32 v17, v17, v241
    v_mul_f32 v18, v18, v241
    v_mul_f32 v19, v19, v241
    v_mul_f32 v28, v28, v241
    v_mul_f32 v29, v29, v241
    v_mul_f32 v30, v30, v241
    v_mul_f32 v31, v31, v241
    v_mul_f32 v40, v40, v241
    v_mul_f32 v41, v41, v241
    v_mul_f32 v42, v42, v241
    v_mul_f32 v43, v43, v241
    v_mul_f32 v52, v52, v241
    v_mul_f32 v53, v53, v241
    v_mul_f32 v54, v54, v241
    v_mul_f32 v55, v55, v241
    v_mul_f32 v64, v64, v241
    v_mul_f32 v65, v65, v241
    v_mul_f32 v66, v66, v241
    v_mul_f32 v67, v67, v241
    v_mul_f32 v76, v76, v241
    v_mul_f32 v77, v77, v241
    v_mul_f32 v78, v78, v241
    v_mul_f32 v79, v79, v241
    v_mul_f32 v88, v88, v241
    v_mul_f32 v89, v89, v241
    v_mul_f32 v90, v90, v241
    v_mul_f32 v91, v91, v241
    v_sub_f32 v176, v176, v239
    v_sub_f32 v177, v177, v239
    v_sub_f32 v178, v178, v239
    v_sub_f32 v179, v179, v239
    v_sub_f32 v188, v188, v239
    v_sub_f32 v189, v189, v239
    v_sub_f32 v190, v190, v239
    v_sub_f32 v191, v191, v239
    v_sub_f32 v152, v152, v239
    v_sub_f32 v153, v153, v239
    v_sub_f32 v154, v154, v239
    v_sub_f32 v155, v155, v239
    v_sub_f32 v164, v164, v239
    v_sub_f32 v165, v165, v239
    v_sub_f32 v166, v166, v239
    v_sub_f32 v167, v167, v239
    v_sub_f32 v232, v232, v239
    v_sub_f32 v233, v233, v239
    v_sub_f32 v234, v234, v239
    v_sub_f32 v235, v235, v239
    v_mul_f32 v253, v253, v242
    v_mul_f32 v8, v8, v242
    v_mul_f32 v9, v9, v242
    v_mul_f32 v10, v10, v242
    v_mul_f32 v11, v11, v242
    v_mul_f32 v20, v20, v242
    v_mul_f32 v21, v21, v242
    v_mul_f32 v22, v22, v242
    v_mul_f32 v23, v23, v242
    v_mul_f32 v32, v32, v242
    v_mul_f32 v33, v33, v242
    v_mul_f32 v34, v34, v242
    v_mul_f32 v35, v35, v242
    v_mul_f32 v44, v44, v242
    v_mul_f32 v45, v45, v242
    v_mul_f32 v46, v46, v242
    v_mul_f32 v47, v47, v242
    v_mul_f32 v56, v56, v242
    v_mul_f32 v57, v57, v242
    v_mul_f32 v58, v58, v242
    v_mul_f32 v59, v59, v242
    v_mul_f32 v68, v68, v242
    v_mul_f32 v69, v69, v242
    v_mul_f32 v70, v70, v242
    v_mul_f32 v71, v71, v242
    v_mul_f32 v80, v80, v242
    v_mul_f32 v81, v81, v242
    v_mul_f32 v82, v82, v242
    v_mul_f32 v83, v83, v242
    v_mul_f32 v92, v92, v242
    v_mul_f32 v93, v93, v242
    v_mul_f32 v94, v94, v242
    v_mul_f32 v95, v95, v242
    v_exp_f32 v168, v168
    v_exp_f32 v169, v169
    v_exp_f32 v170, v170
    v_add_f32 v244, v168, v169
    v_exp_f32 v171, v171
    v_add_f32 v244, v244, v170
    v_cvt_pk_bf16_f32 v168, v168, v169
    v_add_f32 v244, v244, v171
    v_cvt_pk_bf16_f32 v169, v170, v171
    v_exp_f32 v172, v172
    v_exp_f32 v173, v173
    v_exp_f32 v174, v174
    v_add_f32 v245, v172, v173
    v_exp_f32 v175, v175
    v_add_f32 v245, v245, v174
    v_cvt_pk_bf16_f32 v172, v172, v173
    v_add_f32 v245, v245, v175
    v_cvt_pk_bf16_f32 v173, v174, v175
    v_exp_f32 v176, v176
    v_exp_f32 v177, v177
    v_exp_f32 v178, v178
    v_add_f32 v246, v176, v177
    v_exp_f32 v179, v179
    v_add_f32 v246, v246, v178
    v_cvt_pk_bf16_f32 v176, v176, v177
    v_add_f32 v246, v246, v179
    v_cvt_pk_bf16_f32 v177, v178, v179
    v_exp_f32 v180, v180
    v_exp_f32 v181, v181
    v_add_f32 v244, v244, v180
    v_exp_f32 v182, v182
    v_add_f32 v244, v244, v181
    v_exp_f32 v183, v183
    v_add_f32 v244, v244, v182
    v_cvt_pk_bf16_f32 v170, v180, v181
    v_add_f32 v244, v244, v183
    v_cvt_pk_bf16_f32 v171, v182, v183
    v_exp_f32 v184, v184
    v_exp_f32 v185, v185
    v_add_f32 v245, v245, v184
    v_exp_f32 v186, v186
    v_add_f32 v245, v245, v185
    v_exp_f32 v187, v187
    v_add_f32 v245, v245, v186
    v_cvt_pk_bf16_f32 v174, v184, v185
    v_add_f32 v245, v245, v187
    v_cvt_pk_bf16_f32 v175, v186, v187
    v_exp_f32 v188, v188
    v_exp_f32 v189, v189
    v_add_f32 v246, v246, v188
    v_exp_f32 v190, v190
    v_add_f32 v246, v246, v189
    v_exp_f32 v191, v191
    v_add_f32 v246, v246, v190
    v_cvt_pk_bf16_f32 v178, v188, v189
    v_add_f32 v246, v246, v191
    v_cvt_pk_bf16_f32 v179, v190, v191
    s_nop 1
    s_branch P2_JOIN
P4_RARE:
    s_cmp_ge_u32 s45, 65536
    s_cselect_b32 s47, 0, 163840
    s_sub_u32 s47, s47, 65536
    v_add_u32 v243, s47, v248
    ds_read_b128 v[192:195], v243 offset:0
    ds_read_b128 v[196:199], v243 offset:512
    ds_read_b128 v[200:203], v243 offset:1024
    ds_read_b128 v[204:207], v243 offset:1536
    s_waitcnt lgkmcnt(0)
    v_mfma_f32_16x16x32_bf16 v[144:147], v[192:195], v[96:99], v[224:227]
    v_mfma_f32_16x16x32_bf16 v[148:151], v[192:195], v[100:103], v[228:231]
    v_mfma_f32_16x16x32_bf16 v[152:155], v[192:195], v[104:107], v[232:235]
    v_mfma_f32_16x16x32_bf16 v[144:147], v[196:199], v[108:111], v[144:147]
    v_mfma_f32_16x16x32_bf16 v[148:151], v[196:199], v[112:115], v[148:151]
    v_mfma_f32_16x16x32_bf16 v[152:155], v[196:199], v[116:119], v[152:155]
    v_mfma_f32_16x16x32_bf16 v[144:147], v[200:203], v[120:123], v[144:147]
    v_mfma_f32_16x16x32_bf16 v[148:151], v[200:203], v[124:127], v[148:151]
    v_mfma_f32_16x16x32_bf16 v[152:155], v[200:203], v[128:131], v[152:155]
    v_mfma_f32_16x16x32_bf16 v[144:147], v[204:207], v[132:135], v[144:147]
    v_mfma_f32_16x16x32_bf16 v[148:151], v[204:207], v[136:139], v[148:151]
    v_mfma_f32_16x16x32_bf16 v[152:155], v[204:207], v[140:143], v[152:155]
    ds_read_b128 v[192:195], v243 offset:4096
    ds_read_b128 v[196:199], v243 offset:4608
    ds_read_b128 v[200:203], v243 offset:5120
    ds_read_b128 v[204:207], v243 offset:5632
    s_waitcnt lgkmcnt(0)
    v_mfma_f32_16x16x32_bf16 v[156:159], v[192:195], v[96:99], v[224:227]
    v_mfma_f32_16x16x32_bf16 v[160:163], v[192:195], v[100:103], v[228:231]
    v_mfma_f32_16x16x32_bf16 v[164:167], v[192:195], v[104:107], v[232:235]
    v_mfma_f32_16x16x32_bf16 v[156:159], v[196:199], v[108:111], v[156:159]
    v_mfma_f32_16x16x32_bf16 v[160:163], v[196:199], v[112:115], v[160:163]
    v_mfma_f32_16x16x32_bf16 v[164:167], v[196:199], v[116:119], v[164:167]
    v_mfma_f32_16x16x32_bf16 v[156:159], v[200:203], v[120:123], v[156:159]
    v_mfma_f32_16x16x32_bf16 v[160:163], v[200:203], v[124:127], v[160:163]
    v_mfma_f32_16x16x32_bf16 v[164:167], v[200:203], v[128:131], v[164:167]
    v_mfma_f32_16x16x32_bf16 v[156:159], v[204:207], v[132:135], v[156:159]
    v_mfma_f32_16x16x32_bf16 v[160:163], v[204:207], v[136:139], v[160:163]
    v_mfma_f32_16x16x32_bf16 v[164:167], v[204:207], v[140:143], v[164:167]
    s_nop 7
    v_max3_f32 v237, v144, v145, v146
    v_max3_f32 v238, v148, v149, v150
    v_max3_f32 v239, v152, v153, v154
    v_max3_f32 v237, v237, v147, v156
    v_max3_f32 v238, v238, v151, v160
    v_max3_f32 v239, v239, v155, v164
    v_max3_f32 v237, v237, v157, v158
    v_max3_f32 v238, v238, v161, v162
    v_max3_f32 v239, v239, v165, v166
    v_max_f32 v237, v237, v159
    v_max_f32 v238, v238, v163
    v_max_f32 v239, v239, v167
    v_mov_b32 v240, v237
    v_mov_b32 v241, v238
    v_mov_b32 v242, v239
    v_permlane32_swap_b32 v237, v240
    v_permlane32_swap_b32 v238, v241
    v_permlane32_swap_b32 v239, v242
    v_max_f32 v237, v237, v240
    v_max_f32 v238, v238, v241
    v_max_f32 v239, v239, v242
    v_mov_b32 v240, v237
    v_mov_b32 v241, v238
    v_mov_b32 v242, v239
    v_permlane16_swap_b32 v237, v240
    v_permlane16_swap_b32 v238, v241
    v_permlane16_swap_b32 v239, v242
    v_max_f32 v237, v237, v240
    v_max_f32 v238, v238, v241
    v_max_f32 v239, v239, v242
    v_max_f32 v237, 0, v237
    v_max_f32 v238, 0, v238
    v_max_f32 v239, 0, v239
    v_exp_f32 v240, -v237
    v_exp_f32 v241, -v238
    v_exp_f32 v242, -v239
    v_sub_f32 v144, v144, v237
    v_sub_f32 v145, v145, v237
    v_sub_f32 v146, v146, v237
    v_sub_f32 v147, v147, v237
    v_sub_f32 v156, v156, v237
    v_sub_f32 v157, v157, v237
    v_sub_f32 v158, v158, v237
    v_sub_f32 v159, v159, v237
    v_sub_f32 v168, v168, v237
    v_sub_f32 v169, v169, v237
    v_sub_f32 v170, v170, v237
    v_sub_f32 v171, v171, v237
    v_sub_f32 v180, v180, v237
    v_sub_f32 v181, v181, v237
    v_sub_f32 v182, v182, v237
    v_sub_f32 v183, v183, v237
    v_sub_f32 v224, v224, v237
    v_sub_f32 v225, v225, v237
    v_sub_f32 v226, v226, v237
    v_sub_f32 v227, v227, v237
    v_mul_f32 v251, v251, v240
    v_mul_f32 v0, v0, v240
    v_mul_f32 v1, v1, v240
    v_mul_f32 v2, v2, v240
    v_mul_f32 v3, v3, v240
    v_mul_f32 v12, v12, v240
    v_mul_f32 v13, v13, v240
    v_mul_f32 v14, v14, v240
    v_mul_f32 v15, v15, v240
    v_mul_f32 v24, v24, v240
    v_mul_f32 v25, v25, v240
    v_mul_f32 v26, v26, v240
    v_mul_f32 v27, v27, v240
    v_mul_f32 v36, v36, v240
    v_mul_f32 v37, v37, v240
    v_mul_f32 v38, v38, v240
    v_mul_f32 v39, v39, v240
    v_mul_f32 v48, v48, v240
    v_mul_f32 v49, v49, v240
    v_mul_f32 v50, v50, v240
    v_mul_f32 v51, v51, v240
    v_mul_f32 v60, v60, v240
    v_mul_f32 v61, v61, v240
    v_mul_f32 v62, v62, v240
    v_mul_f32 v63, v63, v240
    v_mul_f32 v72, v72, v240
    v_mul_f32 v73, v73, v240
    v_mul_f32 v74, v74, v240
    v_mul_f32 v75, v75, v240
    v_mul_f32 v84, v84, v240
    v_mul_f32 v85, v85, v240
    v_mul_f32 v86, v86, v240
    v_mul_f32 v87, v87, v240
    v_sub_f32 v148, v148, v238
    v_sub_f32 v149, v149, v238
    v_sub_f32 v150, v150, v238
    v_sub_f32 v151, v151, v238
    v_sub_f32 v160, v160, v238
    v_sub_f32 v161, v161, v238
    v_sub_f32 v162, v162, v238
    v_sub_f32 v163, v163, v238
    v_sub_f32 v172, v172, v238
    v_sub_f32 v173, v173, v238
    v_sub_f32 v174, v174, v238
    v_sub_f32 v175, v175, v238
    v_sub_f32 v184, v184, v238
    v_sub_f32 v185, v185, v238
    v_sub_f32 v186, v186, v238
    v_sub_f32 v187, v187, v238
    v_sub_f32 v228, v228, v238
    v_sub_f32 v229, v229, v238
    v_sub_f32 v230, v230, v238
    v_sub_f32 v231, v231, v238
    v_mul_f32 v252, v252, v241
    v_mul_f32 v4, v4, v241
    v_mul_f32 v5, v5, v241
    v_mul_f32 v6, v6, v241
    v_mul_f32 v7, v7, v241
    v_mul_f32 v16, v16, v241
    v_mul_f32 v17, v17, v241
    v_mul_f32 v18, v18, v241
    v_mul_f32 v19, v19, v241
    v_mul_f32 v28, v28, v241
    v_mul_f32 v29, v29, v241
    v_mul_f32 v30, v30, v241
    v_mul_f32 v31, v31, v241
    v_mul_f32 v40, v40, v241
    v_mul_f32 v41, v41, v241
    v_mul_f32 v42, v42, v241
    v_mul_f32 v43, v43, v241
    v_mul_f32 v52, v52, v241
    v_mul_f32 v53, v53, v241
    v_mul_f32 v54, v54, v241
    v_mul_f32 v55, v55, v241
    v_mul_f32 v64, v64, v241
    v_mul_f32 v65, v65, v241
    v_mul_f32 v66, v66, v241
    v_mul_f32 v67, v67, v241
    v_mul_f32 v76, v76, v241
    v_mul_f32 v77, v77, v241
    v_mul_f32 v78, v78, v241
    v_mul_f32 v79, v79, v241
    v_mul_f32 v88, v88, v241
    v_mul_f32 v89, v89, v241
    v_mul_f32 v90, v90, v241
    v_mul_f32 v91, v91, v241
    v_sub_f32 v152, v152, v239
    v_sub_f32 v153, v153, v239
    v_sub_f32 v154, v154, v239
    v_sub_f32 v155, v155, v239
    v_sub_f32 v164, v164, v239
    v_sub_f32 v165, v165, v239
    v_sub_f32 v166, v166, v239
    v_sub_f32 v167, v167, v239
    v_sub_f32 v176, v176, v239
    v_sub_f32 v177, v177, v239
    v_sub_f32 v178, v178, v239
    v_sub_f32 v179, v179, v239
    v_sub_f32 v188, v188, v239
    v_sub_f32 v189, v189, v239
    v_sub_f32 v190, v190, v239
    v_sub_f32 v191, v191, v239
    v_sub_f32 v232, v232, v239
    v_sub_f32 v233, v233, v239
    v_sub_f32 v234, v234, v239
    v_sub_f32 v235, v235, v239
    v_mul_f32 v253, v253, v242
    v_mul_f32 v8, v8, v242
    v_mul_f32 v9, v9, v242
    v_mul_f32 v10, v10, v242
    v_mul_f32 v11, v11, v242
    v_mul_f32 v20, v20, v242
    v_mul_f32 v21, v21, v242
    v_mul_f32 v22, v22, v242
    v_mul_f32 v23, v23, v242
    v_mul_f32 v32, v32, v242
    v_mul_f32 v33, v33, v242
    v_mul_f32 v34, v34, v242
    v_mul_f32 v35, v35, v242
    v_mul_f32 v44, v44, v242
    v_mul_f32 v45, v45, v242
    v_mul_f32 v46, v46, v242
    v_mul_f32 v47, v47, v242
    v_mul_f32 v56, v56, v242
    v_mul_f32 v57, v57, v242
    v_mul_f32 v58, v58, v242
    v_mul_f32 v59, v59, v242
    v_mul_f32 v68, v68, v242
    v_mul_f32 v69, v69, v242
    v_mul_f32 v70, v70, v242
    v_mul_f32 v71, v71, v242
    v_mul_f32 v80, v80, v242
    v_mul_f32 v81, v81, v242
    v_mul_f32 v82, v82, v242
    v_mul_f32 v83, v83, v242
    v_mul_f32 v92, v92, v242
    v_mul_f32 v93, v93, v242
    v_mul_f32 v94, v94, v242
    v_mul_f32 v95, v95, v242
    v_exp_f32 v144, v144
    v_exp_f32 v145, v145
    v_exp_f32 v146, v146
    v_add_f32 v244, v144, v145
    v_exp_f32 v147, v147
    v_add_f32 v244, v244, v146
    v_cvt_pk_bf16_f32 v144, v144, v145
    v_add_f32 v244, v244, v147
    v_cvt_pk_bf16_f32 v145, v146, v147
    v_exp_f32 v148, v148
    v_exp_f32 v149, v149
    v_exp_f32 v150, v150
    v_add_f32 v245, v148, v149
    v_exp_f32 v151, v151
    v_add_f32 v245, v245, v150
    v_cvt_pk_bf16_f32 v148, v148, v149
    v_add_f32 v245, v245, v151
    v_cvt_pk_bf16_f32 v149, v150, v151
    v_exp_f32 v152, v152
    v_exp_f32 v153, v153
    v_exp_f32 v154, v154
    v_add_f32 v246, v152, v153
    v_exp_f32 v155, v155
    v_add_f32 v246, v246, v154
    v_cvt_pk_bf16_f32 v152, v152, v153
    v_add_f32 v246, v246, v155
    v_cvt_pk_bf16_f32 v153, v154, v155
    v_exp_f32 v156, v156
    v_exp_f32 v157, v157
    v_add_f32 v244, v244, v156
    v_exp_f32 v158, v158
    v_add_f32 v244, v244, v157
    v_exp_f32 v159, v159
    v_add_f32 v244, v244, v158
    v_cvt_pk_bf16_f32 v146, v156, v157
    v_add_f32 v244, v244, v159
    v_cvt_pk_bf16_f32 v147, v158, v159
    v_exp_f32 v160, v160
    v_exp_f32 v161, v161
    v_add_f32 v245, v245, v160
    v_exp_f32 v162, v162
    v_add_f32 v245, v245, v161
    v_exp_f32 v163, v163
    v_add_f32 v245, v245, v162
    v_cvt_pk_bf16_f32 v150, v160, v161
    v_add_f32 v245, v245, v163
    v_cvt_pk_bf16_f32 v151, v162, v163
    v_exp_f32 v164, v164
    v_exp_f32 v165, v165
    v_add_f32 v246, v246, v164
    v_exp_f32 v166, v166
    v_add_f32 v246, v246, v165
    v_exp_f32 v167, v167
    v_add_f32 v246, v246, v166
    v_cvt_pk_bf16_f32 v154, v164, v165
    v_add_f32 v246, v246, v167
    v_cvt_pk_bf16_f32 v155, v166, v167
    s_nop 1
    s_branch P4_JOIN
L2_RARE:
    s_cmp_ge_u32 s45, 32768
    s_cselect_b32 s47, 0, 163840
    s_sub_u32 s47, s47, 32768
    v_add_u32 v243, s47, v248
    ds_read_b128 v[192:195], v243 offset:0
    ds_read_b128 v[196:199], v243 offset:512
    ds_read_b128 v[200:203], v243 offset:1024
    ds_read_b128 v[204:207], v243 offset:1536
    s_waitcnt lgkmcnt(0)
    v_mfma_f32_16x16x32_bf16 v[168:171], v[192:195], v[96:99], v[224:227]
    v_mfma_f32_16x16x32_bf16 v[172:175], v[192:195], v[100:103], v[228:231]
    v_mfma_f32_16x16x32_bf16 v[176:179], v[192:195], v[104:107], v[232:235]
    v_mfma_f32_16x16x32_bf16 v[168:171], v[196:199], v[108:111], v[168:171]
    v_mfma_f32_16x16x32_bf16 v[172:175], v[196:199], v[112:115], v[172:175]
    v_mfma_f32_16x16x32_bf16 v[176:179], v[196:199], v[116:119], v[176:179]
    v_mfma_f32_16x16x32_bf16 v[168:171], v[200:203], v[120:123], v[168:171]
    v_mfma_f32_16x16x32_bf16 v[172:175], v[200:203], v[124:127], v[172:175]
    v_mfma_f32_16x16x32_bf16 v[176:179], v[200:203], v[128:131], v[176:179]
    v_mfma_f32_16x16x32_bf16 v[168:171], v[204:207], v[132:135], v[168:171]
    v_mfma_f32_16x16x32_bf16 v[172:175], v[204:207], v[136:139], v[172:175]
    v_mfma_f32_16x16x32_bf16 v[176:179], v[204:207], v[140:143], v[176:179]
    ds_read_b128 v[192:195], v243 offset:4096
    ds_read_b128 v[196:199], v243 offset:4608
    ds_read_b128 v[200:203], v243 offset:5120
    ds_read_b128 v[204:207], v243 offset:5632
    s_waitcnt lgkmcnt(0)
    v_mfma_f32_16x16x32_bf16 v[180:183], v[192:195], v[96:99], v[224:227]
    v_mfma_f32_16x16x32_bf16 v[184:187], v[192:195], v[100:103], v[228:231]
    v_mfma_f32_16x16x32_bf16 v[188:191], v[192:195], v[104:107], v[232:235]
    v_mfma_f32_16x16x32_bf16 v[180:183], v[196:199], v[108:111], v[180:183]
    v_mfma_f32_16x16x32_bf16 v[184:187], v[196:199], v[112:115], v[184:187]
    v_mfma_f32_16x16x32_bf16 v[188:191], v[196:199], v[116:119], v[188:191]
    v_mfma_f32_16x16x32_bf16 v[180:183], v[200:203], v[120:123], v[180:183]
    v_mfma_f32_16x16x32_bf16 v[184:187], v[200:203], v[124:127], v[184:187]
    v_mfma_f32_16x16x32_bf16 v[188:191], v[200:203], v[128:131], v[188:191]
    v_mfma_f32_16x16x32_bf16 v[180:183], v[204:207], v[132:135], v[180:183]
    v_mfma_f32_16x16x32_bf16 v[184:187], v[204:207], v[136:139], v[184:187]
    v_mfma_f32_16x16x32_bf16 v[188:191], v[204:207], v[140:143], v[188:191]
    s_nop 7
    v_max3_f32 v237, v168, v169, v170
    v_max3_f32 v238, v172, v173, v174
    v_max3_f32 v239, v176, v177, v178
    v_max3_f32 v237, v237, v171, v180
    v_max3_f32 v238, v238, v175, v184
    v_max3_f32 v239, v239, v179, v188
    v_max3_f32 v237, v237, v181, v182
    v_max3_f32 v238, v238, v185, v186
    v_max3_f32 v239, v239, v189, v190
    v_max_f32 v237, v237, v183
    v_max_f32 v238, v238, v187
    v_max_f32 v239, v239, v191
    v_mov_b32 v240, v237
    v_mov_b32 v241, v238
    v_mov_b32 v242, v239
    v_permlane32_swap_b32 v237, v240
    v_permlane32_swap_b32 v238, v241
    v_permlane32_swap_b32 v239, v242
    v_max_f32 v237, v237, v240
    v_max_f32 v238, v238, v241
    v_max_f32 v239, v239, v242
    v_mov_b32 v240, v237
    v_mov_b32 v241, v238
    v_mov_b32 v242, v239
    v_permlane16_swap_b32 v237, v240
    v_permlane16_swap_b32 v238, v241
    v_permlane16_swap_b32 v239, v242
    v_max_f32 v237, v237, v240
    v_max_f32 v238, v238, v241
    v_max_f32 v239, v239, v242
    v_max_f32 v237, 0, v237
    v_max_f32 v238, 0, v238
    v_max_f32 v239, 0, v239
    v_exp_f32 v240, -v237
    v_exp_f32 v241, -v238
    v_exp_f32 v242, -v239
    v_sub_f32 v168, v168, v237
    v_sub_f32 v169, v169, v237
    v_sub_f32 v170, v170, v237
    v_sub_f32 v171, v171, v237
    v_sub_f32 v180, v180, v237
    v_sub_f32 v181, v181, v237
    v_sub_f32 v182, v182, v237
    v_sub_f32 v183, v183, v237
    v_sub_f32 v224, v224, v237
    v_sub_f32 v225, v225, v237
    v_sub_f32 v226, v226, v237
    v_sub_f32 v227, v227, v237
    v_mul_f32 v251, v251, v240
    v_mul_f32 v0, v0, v240
    v_mul_f32 v1, v1, v240
    v_mul_f32 v2, v2, v240
    v_mul_f32 v3, v3, v240
    v_mul_f32 v12, v12, v240
    v_mul_f32 v13, v13, v240
    v_mul_f32 v14, v14, v240
    v_mul_f32 v15, v15, v240
    v_mul_f32 v24, v24, v240
    v_mul_f32 v25, v25, v240
    v_mul_f32 v26, v26, v240
    v_mul_f32 v27, v27, v240
    v_mul_f32 v36, v36, v240
    v_mul_f32 v37, v37, v240
    v_mul_f32 v38, v38, v240
    v_mul_f32 v39, v39, v240
    v_mul_f32 v48, v48, v240
    v_mul_f32 v49, v49, v240
    v_mul_f32 v50, v50, v240
    v_mul_f32 v51, v51, v240
    v_mul_f32 v60, v60, v240
    v_mul_f32 v61, v61, v240
    v_mul_f32 v62, v62, v240
    v_mul_f32 v63, v63, v240
    v_mul_f32 v72, v72, v240
    v_mul_f32 v73, v73, v240
    v_mul_f32 v74, v74, v240
    v_mul_f32 v75, v75, v240
    v_mul_f32 v84, v84, v240
    v_mul_f32 v85, v85, v240
    v_mul_f32 v86, v86, v240
    v_mul_f32 v87, v87, v240
    v_sub_f32 v172, v172, v238
    v_sub_f32 v173, v173, v238
    v_sub_f32 v174, v174, v238
    v_sub_f32 v175, v175, v238
    v_sub_f32 v184, v184, v238
    v_sub_f32 v185, v185, v238
    v_sub_f32 v186, v186, v238
    v_sub_f32 v187, v187, v238
    v_sub_f32 v228, v228, v238
    v_sub_f32 v229, v229, v238
    v_sub_f32 v230, v230, v238
    v_sub_f32 v231, v231, v238
    v_mul_f32 v252, v252, v241
    v_mul_f32 v4, v4, v241
    v_mul_f32 v5, v5, v241
    v_mul_f32 v6, v6, v241
    v_mul_f32 v7, v7, v241
    v_mul_f32 v16, v16, v241
    v_mul_f32 v17, v17, v241
    v_mul_f32 v18, v18, v241
    v_mul_f32 v19, v19, v241
    v_mul_f32 v28, v28, v241
    v_mul_f32 v29, v29, v241
    v_mul_f32 v30, v30, v241
    v_mul_f32 v31, v31, v241
    v_mul_f32 v40, v40, v241
    v_mul_f32 v41, v41, v241
    v_mul_f32 v42, v42, v241
    v_mul_f32 v43, v43, v241
    v_mul_f32 v52, v52, v241
    v_mul_f32 v53, v53, v241
    v_mul_f32 v54, v54, v241
    v_mul_f32 v55, v55, v241
    v_mul_f32 v64, v64, v241
    v_mul_f32 v65, v65, v241
    v_mul_f32 v66, v66, v241
    v_mul_f32 v67, v67, v241
    v_mul_f32 v76, v76, v241
    v_mul_f32 v77, v77, v241
    v_mul_f32 v78, v78, v241
    v_mul_f32 v79, v79, v241
    v_mul_f32 v88, v88, v241
    v_mul_f32 v89, v89, v241
    v_mul_f32 v90, v90, v241
    v_mul_f32 v91, v91, v241
    v_sub_f32 v176, v176, v239
    v_sub_f32 v177, v177, v239
    v_sub_f32 v178, v178, v239
    v_sub_f32 v179, v179, v239
    v_sub_f32 v188, v188, v239
    v_sub_f32 v189, v189, v239
    v_sub_f32 v190, v190, v239
    v_sub_f32 v191, v191, v239
    v_sub_f32 v232, v232, v239
    v_sub_f32 v233, v233, v239
    v_sub_f32 v234, v234, v239
    v_sub_f32 v235, v235, v239
    v_mul_f32 v253, v253, v242
    v_mul_f32 v8, v8, v242
    v_mul_f32 v9, v9, v242
    v_mul_f32 v10, v10, v242
    v_mul_f32 v11, v11, v242
    v_mul_f32 v20, v20, v242
    v_mul_f32 v21, v21, v242
    v_mul_f32 v22, v22, v242
    v_mul_f32 v23, v23, v242
    v_mul_f32 v32, v32, v242
    v_mul_f32 v33, v33, v242
    v_mul_f32 v34, v34, v242
    v_mul_f32 v35, v35, v242
    v_mul_f32 v44, v44, v242
    v_mul_f32 v45, v45, v242
    v_mul_f32 v46, v46, v242
    v_mul_f32 v47, v47, v242
    v_mul_f32 v56, v56, v242
    v_mul_f32 v57, v57, v242
    v_mul_f32 v58, v58, v242
    v_mul_f32 v59, v59, v242
    v_mul_f32 v68, v68, v242
    v_mul_f32 v69, v69, v242
    v_mul_f32 v70, v70, v242
    v_mul_f32 v71, v71, v242
    v_mul_f32 v80, v80, v242
    v_mul_f32 v81, v81, v242
    v_mul_f32 v82, v82, v242
    v_mul_f32 v83, v83, v242
    v_mul_f32 v92, v92, v242
    v_mul_f32 v93, v93, v242
    v_mul_f32 v94, v94, v242
    v_mul_f32 v95, v95, v242
    v_exp_f32 v168, v168
    v_exp_f32 v169, v169
    v_exp_f32 v170, v170
    v_add_f32 v244, v168, v169
    v_exp_f32 v171, v171
    v_add_f32 v244, v244, v170
    v_cvt_pk_bf16_f32 v168, v168, v169
    v_add_f32 v244, v244, v171
    v_cvt_pk_bf16_f32 v169, v170, v171
    v_exp_f32 v172, v172
    v_exp_f32 v173, v173
    v_exp_f32 v174, v174
    v_add_f32 v245, v172, v173
    v_exp_f32 v175, v175
    v_add_f32 v245, v245, v174
    v_cvt_pk_bf16_f32 v172, v172, v173
    v_add_f32 v245, v245, v175
    v_cvt_pk_bf16_f32 v173, v174, v175
    v_exp_f32 v176, v176
    v_exp_f32 v177, v177
    v_exp_f32 v178, v178
    v_add_f32 v246, v176, v177
    v_exp_f32 v179, v179
    v_add_f32 v246, v246, v178
    v_cvt_pk_bf16_f32 v176, v176, v177
    v_add_f32 v246, v246, v179
    v_cvt_pk_bf16_f32 v177, v178, v179
    v_exp_f32 v180, v180
    v_exp_f32 v181, v181
    v_add_f32 v244, v244, v180
    v_exp_f32 v182, v182
    v_add_f32 v244, v244, v181
    v_exp_f32 v183, v183
    v_add_f32 v244, v244, v182
    v_cvt_pk_bf16_f32 v170, v180, v181
    v_add_f32 v244, v244, v183
    v_cvt_pk_bf16_f32 v171, v182, v183
    v_exp_f32 v184, v184
    v_exp_f32 v185, v185
    v_add_f32 v245, v245, v184
    v_exp_f32 v186, v186
    v_add_f32 v245, v245, v185
    v_exp_f32 v187, v187
    v_add_f32 v245, v245, v186
    v_cvt_pk_bf16_f32 v174, v184, v185
    v_add_f32 v245, v245, v187
    v_cvt_pk_bf16_f32 v175, v186, v187
    v_exp_f32 v188, v188
    v_exp_f32 v189, v189
    v_add_f32 v246, v246, v188
    v_exp_f32 v190, v190
    v_add_f32 v246, v246, v189
    v_exp_f32 v191, v191
    v_add_f32 v246, v246, v190
    v_cvt_pk_bf16_f32 v178, v188, v189
    v_add_f32 v246, v246, v191
    v_cvt_pk_bf16_f32 v179, v190, v191
    s_nop 1
    s_branch L2_JOIN
.section .rodata,"a"
.p2align 6
.amdhsa_kernel standalone__mha_block_cached__near_ridge_kernel
  .amdhsa_next_free_vgpr 256
  .amdhsa_next_free_sgpr 102
  .amdhsa_accum_offset 256
  .amdhsa_group_segment_fixed_size 0
  .amdhsa_kernarg_size 64
  .amdhsa_user_sgpr_count 2
  .amdhsa_user_sgpr_kernarg_segment_ptr 1
  .amdhsa_system_sgpr_workgroup_id_x 1
.end_amdhsa_kernel
```
